```python
import torch

def _softmax(x, axis=-1):
    return torch.softmax(x, dim=axis)
def _gelu(x):
    return torch.nn.functional.gelu(x, approximate="tanh")
def _silu(x):
    return torch.nn.functional.silu(x)
def _sigmoid(x):
    return torch.sigmoid(x)
def _layernorm(x, axis=-1, eps=1e-5):
    m = x.mean(dim=axis, keepdim=True)
    v = x.var(dim=axis, keepdim=True, unbiased=False)
    return (x - m) / torch.sqrt(v + eps)
def _scatter_add(tgt, idx, src, axis=0):
    return tgt.clone().index_add_(axis, idx, src)
def _segment_sum(src, seg, n):
    out = torch.zeros((n,) + src.shape[1:], dtype=src.dtype)
    return out.index_add_(0, seg, src)
def _pad(x, pw):
    flat = tuple(v for pair in reversed(pw) for v in pair)
    return torch.nn.functional.pad(x, flat)

kernel_name = 'gather_scatter__edge_featured_mpnn_egc__graph'

def setup_inputs():

    _w = (lambda a: (lambda t: t.to(torch.bfloat16) if t.is_floating_point() else t)(torch.as_tensor(a)))
    N, deg, D, De = 25000, 32, 64, max(16, 1)
    E = N * deg
    return {
        "x": _w((lambda *s: torch.randn(*s, dtype=torch.bfloat16) * 0.2)(N, D)),
        "e_attr": _w((lambda *s: torch.randn(*s, dtype=torch.bfloat16) * 0.2)(E, De)),
        "src": _w((lambda lo, hi, *s: torch.randint(lo, hi, s))(0, N, E).to(torch.int64)),
        "dst": _w((lambda lo, hi, *s: torch.randint(lo, hi, s))(0, N, E).to(torch.int64)),
        "u_w": _w((lambda *s: torch.randn(*s, dtype=torch.bfloat16) * 0.05)(D, D)),
        "v_w": _w((lambda *s: torch.randn(*s, dtype=torch.bfloat16) * 0.05)(D, D)),
        "g_w": _w((lambda *s: torch.randn(*s, dtype=torch.bfloat16) * 0.2)(2 * D + De, D)),
    }

def reference(x, e_attr, src, dst, u_w, v_w, g_w):
    N, D = x.shape
    g_in = torch.concatenate([x[dst], x[src], e_attr], axis=-1)
    eta = _sigmoid(g_in @ g_w)
    hv = x @ v_w
    msg = eta * hv[src]
    agg = _segment_sum(msg, dst, N)
    return _silu(x @ u_w + agg)
```

```asm
; @launch grid=(256,1,1) block=(512,1,1) lds=161408
.amdgcn_target "amdgcn-amd-amdhsa--gfx950"
.text
.globl gather_scatter__edge_featured_mpnn_egc__graph_kernel
.p2align 8
.type gather_scatter__edge_featured_mpnn_egc__graph_kernel,@function
gather_scatter__edge_featured_mpnn_egc__graph_kernel:
    s_cmp_ge_u32 s2, 256
    s_cbranch_scc1 K_END
    s_load_dwordx16 s[4:19], s[0:1], 0
    s_load_dwordx4 s[20:23], s[0:1], 64
    s_memrealtime s[62:63]
    v_readfirstlane_b32 s48, v0
    s_and_b32 s49, s2, 7
    s_lshr_b32 s50, s2, 3
    s_lshr_b32 s48, s48, 6
    s_cmp_lg_u32 s48, 7
    s_cbranch_scc1 NOCW
    s_getpc_b64 s[60:61]
    v_and_b32 v16, 63, v0
    v_lshlrev_b32 v16, 7, v16
    v_mov_b32 v17, s61
    v_add_co_u32 v16, vcc, s60, v16
    s_nop 1
    v_addc_co_u32 v17, vcc, 0, v17, vcc
    global_load_dword v7, v[16:17], off
    v_add_co_u32 v16, vcc, 0x2000, v16
    s_nop 1
    v_addc_co_u32 v17, vcc, 0, v17, vcc
    global_load_dword v7, v[16:17], off
NOCW:
    s_lshl_b32 s57, s49, 5
    s_add_u32 s57, s57, s50
    s_mov_b32 s58, s57
    s_lshl_b32 s3, s48, 12
    s_add_u32 s3, s3, 34944
    v_lshlrev_b32 v28, 4, v0
    v_lshlrev_b32 v24, 2, v0
    v_mov_b32 v20, 0
    ds_write_b32 v24, v20 offset:34944
    v_mov_b32 v10, 0x7ffffff0
    v_cmp_gt_u32 vcc, 400, v0
    s_mul_i32 s64, s2, 12800
    s_mov_b64 s[66:67], vcc
    v_cndmask_b32 v29, v10, v28, vcc
    s_add_u32 s65, s64, 6400
    v_and_b32 v1, 63, v0
    v_lshlrev_b32 v9, 4, v1
    v_lshrrev_b32 v21, 3, v1
    v_and_b32 v21, 6, v21
    v_and_b32 v22, 7, v1
    v_xor_b32 v21, v21, v22
    v_lshlrev_b32 v21, 4, v21
    v_xor_b32 v250, 0xc00, v21
    v_xor_b32 v251, 0x800, v21
    v_xor_b32 v252, 0x410, v21
    v_xor_b32 v253, 0x10, v21
    s_waitcnt lgkmcnt(0)
    s_mov_b32 s72, s20
    s_and_b32 s73, s21, 0xffff
    s_mov_b32 s74, 256
    s_mov_b32 s75, 0x20000
    s_or_b32 s60, s2, s48
    s_cmp_lg_u32 s60, 0
    s_cbranch_scc1 NONONCE
    s_or_b32 s62, s62, 0x80000000
    v_mov_b32 v16, s62
    s_mov_b64 exec, 1
    buffer_store_dword v16, off, s[72:75], 0 sc1
    s_mov_b64 exec, -1
NONONCE:
    s_mov_b32 s68, s10
    s_and_b32 s69, s11, 0xffff
    s_mov_b32 s70, 3200000
    s_mov_b32 s71, 0x20000
    buffer_load_dwordx4 v[40:43], v29, s[68:71], s64 offen
    buffer_load_dwordx4 v[44:47], v29, s[68:71], s65 offen
    s_mov_b32 s76, s8
    s_and_b32 s77, s9, 0xffff
    s_mov_b32 s78, 3200000
    s_mov_b32 s79, 0x20000
    s_sub_u32 s24, s4, 3072
    s_subb_u32 s25, s5, 0
    s_and_b32 s25, s25, 0xffff
    s_mov_b32 s26, 3203072
    s_mov_b32 s27, 0x20000
    s_mov_b32 s20, 0
    s_barrier
    buffer_load_dwordx4 v[48:51], v29, s[76:79], s64 offen
    buffer_load_dwordx4 v[52:55], v29, s[76:79], s65 offen
    s_cmp_eq_u32 s48, 7
    s_cbranch_scc1 RAW1
NORAW:
    s_mov_b32 m0, s3
    s_mov_b32 s32, s22
    s_and_b32 s33, s23, 0xffff
    s_mov_b32 s34, 6432000
    s_mov_b32 s35, 0x20000
    s_add_u32 s36, s22, 6586368
    s_addc_u32 s37, s23, 0
    s_and_b32 s37, s37, 0xffff
    s_mov_b32 s38, 557056
    s_mov_b32 s39, 0x20000
    s_mov_b32 s52, 0
    s_movk_i32 s55, 128
    s_movk_i32 s11, 48
    s_mov_b32 s53, 0
    s_movk_i32 s54, 4096
    s_mov_b32 s10, 6
    s_mov_b32 s9, 524288
    v_mov_b32 v14, 0
    v_mov_b32 v15, 0
    v_and_b32 v16, 15, v1
    v_lshrrev_b32 v11, 4, v1
    v_lshlrev_b32 v18, 3, v16
    v_add_u32 v6, 67712, v18
    v_lshrrev_b32 v18, 2, v16
    v_and_b32 v19, 1, v16
    v_bfe_u32 v20, v16, 1, 1
    v_lshrrev_b32 v21, 1, v11
    v_lshlrev_b32 v249, 4, v21
    v_and_b32 v21, 1, v11
    v_lshl_add_u32 v21, v20, 1, v21
    v_lshl_add_u32 v21, v19, 2, v21
    v_lshl_add_u32 v5, v18, 3, v21
    v_lshl_add_u32 v21, v18, 1, v20
    v_xor_b32 v21, v21, v11
    v_lshlrev_b32 v21, 4, v21
    v_lshl_add_u32 v22, v18, 1, v19
    v_lshl_add_u32 v22, v20, 4, v22
    v_lshl_add_u32 v8, v22, 7, v21
    v_add_u32 v12, s3, v8
    v_xor_b32 v13, 64, v12
    v_cmp_eq_u32 vcc, v18, v11
    v_mov_b32 v22, 0x3f803f80
    s_nop 0
    v_cndmask_b32 v22, 0, v22, vcc
    v_mul_lo_u32 v201, v22, v19
    v_sub_u32 v200, v22, v201
    v_mov_b32 v206, v200
    v_mov_b32 v207, v201
    v_mov_b32 v212, v200
    v_mov_b32 v213, v201
    v_mov_b32 v218, v200
    v_mov_b32 v219, v201
    s_mov_b32 s28, s6
    s_and_b32 s29, s7, 0xffff
    s_or_b32 s29, s29, 0x200000
    s_mov_b32 s30, 800000
    s_mov_b32 s31, 0x20000
    s_mov_b32 s44, s18
    s_and_b32 s45, s19, 0xffff
    s_mov_b32 s46, 3200000
    s_mov_b32 s47, 0x20000
    v_mov_b32 v20, -1
    v_mov_b32 v21, 0xffff
    v_mov_b32 v22, -1
    v_mov_b32 v23, 0xffff
    v_lshlrev_b32 v24, 4, v0
    ds_write_b128 v24, v[20:23] offset:2176
    ds_write_b128 v24, v[20:23] offset:10368
    ds_write_b128 v24, v[20:23] offset:18560
    ds_write_b128 v24, v[20:23] offset:26752
    v_mov_b32 v26, 0
    v_mov_b32 v27, 0
    v_lshlrev_b32 v25, 3, v0
    v_min_u32 v25, 2152, v25
    ds_write_b64 v25, v[26:27] offset:16
    s_lshl_b32 s60, s48, 8
    v_lshl_add_u32 v3, v5, 3, s60
    v_lshl_add_u32 v4, v11, 6, s60
    v_lshrrev_b32 v21, 3, v1
    v_lshl_add_u32 v2, v21, 5, s60
    v_lshlrev_b32 v31, 2, v0
    v_add_u32 v72, 0, v31
    v_add_u32 v74, 1, v31
    v_add_u32 v76, 2, v31
    v_add_u32 v78, 3, v31
    v_add_u32 v80, 1600, v31
    v_add_u32 v82, 1601, v31
    v_add_u32 v84, 1602, v31
    v_add_u32 v86, 1603, v31
    v_mov_b32 v29, 2
    v_mov_b32 v30, 1
    s_cmp_ge_u32 s2, 250
    s_cbranch_scc1 PH0
    s_mov_b64 exec, s[66:67]
    s_cbranch_execz PH0
    s_waitcnt vmcnt(2)
    v_lshlrev_b32_sdwa v56, v29, v40 dst_sel:DWORD dst_unused:UNUSED_PAD src0_sel:DWORD src1_sel:BYTE_0
    ds_add_rtn_u32 v64, v56, v30 offset:34944
    v_lshlrev_b32_sdwa v57, v29, v41 dst_sel:DWORD dst_unused:UNUSED_PAD src0_sel:DWORD src1_sel:BYTE_0
    ds_add_rtn_u32 v65, v57, v30 offset:34944
    v_lshlrev_b32_sdwa v58, v29, v42 dst_sel:DWORD dst_unused:UNUSED_PAD src0_sel:DWORD src1_sel:BYTE_0
    ds_add_rtn_u32 v66, v58, v30 offset:34944
    v_lshlrev_b32_sdwa v59, v29, v43 dst_sel:DWORD dst_unused:UNUSED_PAD src0_sel:DWORD src1_sel:BYTE_0
    ds_add_rtn_u32 v67, v59, v30 offset:34944
    v_lshlrev_b32_sdwa v60, v29, v44 dst_sel:DWORD dst_unused:UNUSED_PAD src0_sel:DWORD src1_sel:BYTE_0
    ds_add_rtn_u32 v68, v60, v30 offset:34944
    v_lshlrev_b32_sdwa v61, v29, v45 dst_sel:DWORD dst_unused:UNUSED_PAD src0_sel:DWORD src1_sel:BYTE_0
    ds_add_rtn_u32 v69, v61, v30 offset:34944
    v_lshlrev_b32_sdwa v62, v29, v46 dst_sel:DWORD dst_unused:UNUSED_PAD src0_sel:DWORD src1_sel:BYTE_0
    ds_add_rtn_u32 v70, v62, v30 offset:34944
    v_lshlrev_b32_sdwa v63, v29, v47 dst_sel:DWORD dst_unused:UNUSED_PAD src0_sel:DWORD src1_sel:BYTE_0
    ds_add_rtn_u32 v71, v63, v30 offset:34944
    v_lshrrev_b32 v40, 8, v40
    v_lshrrev_b32 v41, 8, v41
    v_lshrrev_b32 v42, 8, v42
    v_lshrrev_b32 v43, 8, v43
    v_lshrrev_b32 v44, 8, v44
    v_lshrrev_b32 v45, 8, v45
    v_lshrrev_b32 v46, 8, v46
    v_lshrrev_b32 v47, 8, v47
PH0:
    s_mov_b64 exec, -1
    s_waitcnt lgkmcnt(0)
    s_barrier
    s_cmp_eq_u32 s48, 7
    s_cbranch_scc1 RAW2
    ds_read_b128 v[20:23], v9 offset:34944
    s_waitcnt lgkmcnt(0)
    v_add_u32 v24, v20, v21
    v_add3_u32 v24, v24, v22, v23
    s_nop 1
    v_add_u32_dpp v24, v24, v24 row_shr:1 row_mask:0xf bank_mask:0xf
    s_nop 1
    v_add_u32_dpp v24, v24, v24 row_shr:2 row_mask:0xf bank_mask:0xf
    s_nop 1
    v_add_u32_dpp v24, v24, v24 row_shr:4 row_mask:0xf bank_mask:0xf
    s_nop 1
    v_add_u32_dpp v24, v24, v24 row_shr:8 row_mask:0xf bank_mask:0xf
    s_nop 1
    v_add_u32_dpp v24, v24, v24 row_bcast:15 row_mask:0xa bank_mask:0xf
    s_nop 1
    v_add_u32_dpp v24, v24, v24 row_bcast:31 row_mask:0xc bank_mask:0xf
    v_sub_u32 v27, v24, v23
    v_sub_u32 v26, v27, v22
    v_sub_u32 v25, v26, v21
    v_sub_u32 v24, v25, v20
    ds_write_b128 v9, v[24:27] offset:35968
    v_lshl_or_b32 v32, v20, 16, v24
    v_lshl_or_b32 v34, v21, 16, v25
    v_lshl_or_b32 v36, v22, 16, v26
    v_lshl_or_b32 v38, v23, 16, v27
    s_cmp_ge_u32 s2, 250
    s_cbranch_scc1 PH1
    ds_read_b32 v56, v56 offset:35968
    ds_read_b32 v57, v57 offset:35968
    ds_read_b32 v58, v58 offset:35968
    ds_read_b32 v59, v59 offset:35968
    ds_read_b32 v60, v60 offset:35968
    ds_read_b32 v61, v61 offset:35968
    ds_read_b32 v62, v62 offset:35968
    ds_read_b32 v63, v63 offset:35968
    s_waitcnt vmcnt(0)
    s_mov_b32 s61, 0xc0000
    v_mul_u32_u24 v19, 41, v48
    v_lshl_or_b32 v73, v40, 20, v48
    v_and_or_b32 v73, v19, s61, v73
    v_mul_u32_u24 v19, 41, v49
    v_lshl_or_b32 v75, v41, 20, v49
    v_and_or_b32 v75, v19, s61, v75
    v_mul_u32_u24 v19, 41, v50
    v_lshl_or_b32 v77, v42, 20, v50
    v_and_or_b32 v77, v19, s61, v77
    v_mul_u32_u24 v19, 41, v51
    v_lshl_or_b32 v79, v43, 20, v51
    v_and_or_b32 v79, v19, s61, v79
    v_mul_u32_u24 v19, 41, v52
    v_lshl_or_b32 v81, v44, 20, v52
    v_and_or_b32 v81, v19, s61, v81
    v_mul_u32_u24 v19, 41, v53
    v_lshl_or_b32 v83, v45, 20, v53
    v_and_or_b32 v83, v19, s61, v83
    v_mul_u32_u24 v19, 41, v54
    v_lshl_or_b32 v85, v46, 20, v54
    v_and_or_b32 v85, v19, s61, v85
    v_mul_u32_u24 v19, 41, v55
    v_lshl_or_b32 v87, v47, 20, v55
    v_and_or_b32 v87, v19, s61, v87
    s_waitcnt lgkmcnt(0)
    s_mov_b64 exec, s[66:67]
    v_add_lshl_u32 v56, v56, v64, 3
    ds_write_b64 v56, v[72:73] offset:36992
    v_add_lshl_u32 v57, v57, v65, 3
    ds_write_b64 v57, v[74:75] offset:36992
    v_add_lshl_u32 v58, v58, v66, 3
    ds_write_b64 v58, v[76:77] offset:36992
    v_add_lshl_u32 v59, v59, v67, 3
    ds_write_b64 v59, v[78:79] offset:36992
    v_add_lshl_u32 v60, v60, v68, 3
    ds_write_b64 v60, v[80:81] offset:36992
    v_add_lshl_u32 v61, v61, v69, 3
    ds_write_b64 v61, v[82:83] offset:36992
    v_add_lshl_u32 v62, v62, v70, 3
    ds_write_b64 v62, v[84:85] offset:36992
    v_add_lshl_u32 v63, v63, v71, 3
    ds_write_b64 v63, v[86:87] offset:36992
    s_mov_b64 exec, -1
PH1:
NOPOLL1:
    v_cmp_gt_u32 vcc, 64, v0
    s_mul_i32 s64, s2, 25728
    s_add_u32 s65, s64, 8192
    s_add_u32 s66, s64, 16384
    s_add_u32 s67, s64, 24576
    v_cndmask_b32 v29, v10, v28, vcc
    v_mov_b32 v17, 0
    s_mul_i32 s63, s2, 2176
    v_lshlrev_b32 v20, 5, v1
    s_waitcnt lgkmcnt(0)
    s_barrier
    ds_read_b32 v33, v17
    ds_read_b128 v[40:43], v28 offset:36992
    ds_read_b128 v[44:47], v28 offset:45184
    ds_read_b128 v[48:51], v28 offset:53376
    ds_read_b128 v[52:55], v28 offset:61568
    s_waitcnt lgkmcnt(4)
    v_readfirstlane_b32 s8, v33
    v_xor_b32 v35, v34, v33
    v_xor_b32 v37, v36, v33
    v_xor_b32 v39, v38, v33
    v_xor_b32 v33, v32, v33
    s_lshl_b32 s59, s8, 4
    s_and_b32 s59, s59, 0xfffff000
    s_lshl_b32 s60, s8, 23
    s_and_b32 s60, s60, 0x78000000
    s_lshr_b32 s61, s8, 12
    s_and_b32 s61, s61, 0x30000
    s_or_b32 s60, s60, s61
    s_andn2_b32 s21, 0x80000000, s59
    s_or_b32 s21, s21, s60
    s_cmp_lg_u32 s48, 6
    s_cbranch_scc1 PUBDA
    buffer_store_dwordx4 v[32:35], v20, s[36:39], s63 offen sc1
    buffer_store_dwordx4 v[36:39], v20, s[36:39], s63 offen offset:16 sc1
PUBDA:
    s_waitcnt lgkmcnt(3)
    v_or_b32 v40, s59, v40
    v_or_b32 v41, s21, v41
    v_or_b32 v42, s59, v42
    v_or_b32 v43, s21, v43
    buffer_store_dwordx4 v[40:43], v28, s[32:35], s64 offen sc1
    s_waitcnt lgkmcnt(2)
    v_or_b32 v44, s59, v44
    v_or_b32 v45, s21, v45
    v_or_b32 v46, s59, v46
    v_or_b32 v47, s21, v47
    buffer_store_dwordx4 v[44:47], v28, s[32:35], s65 offen sc1
    s_waitcnt lgkmcnt(1)
    v_or_b32 v48, s59, v48
    v_or_b32 v49, s21, v49
    v_or_b32 v50, s59, v50
    v_or_b32 v51, s21, v51
    buffer_store_dwordx4 v[48:51], v28, s[32:35], s66 offen sc1
    s_waitcnt lgkmcnt(0)
    v_or_b32 v52, s59, v52
    v_or_b32 v53, s21, v53
    v_or_b32 v54, s59, v54
    v_or_b32 v55, s21, v55
    buffer_store_dwordx4 v[52:55], v29, s[32:35], s67 offen sc1
    v_bfe_u32 v17, v1, 2, 2
    v_and_b32 v18, 3, v1
    v_lshlrev_b32 v18, 3, v18
    v_lshl_add_u32 v18, v17, 7, v18
    s_and_b32 s60, s48, 1
    s_lshr_b32 s61, s48, 1
    s_lshl_b32 s62, s60, 12
    s_lshl_b32 s61, s61, 5
    s_add_u32 s61, s61, s62
    s_add_u32 s61, s61, 100480
    v_lshl_add_u32 v17, v11, 10, v18
    v_add_u32 v17, s61, v17
    s_lshl_b32 s61, s60, 6
    s_add_u32 s61, s61, 116864
    v_lshl_add_u32 v18, v11, 9, v18
    v_add_u32 v18, s61, v18
    ds_read_b64_tr_b16 v[120:121], v17 offset:8192
    ds_read_b64_tr_b16 v[122:123], v17 offset:8704
    ds_read_b64_tr_b16 v[124:125], v18
    ds_read_b64_tr_b16 v[126:127], v18 offset:32
    ds_read_b64_tr_b16 v[128:129], v17 offset:24576
    ds_read_b64_tr_b16 v[130:131], v17 offset:25088
    ds_read_b64_tr_b16 v[132:133], v17
    ds_read_b64_tr_b16 v[134:135], v17 offset:512
    ds_read_b64_tr_b16 v[136:137], v17 offset:32768
    ds_read_b64_tr_b16 v[138:139], v17 offset:33280
    s_lshl_b32 s61, s48, 10
    s_add_u32 s62, s61, 142976
    v_add_u32 v17, s62, v9
    s_add_u32 s62, s61, 84096
    v_add_u32 v18, s62, v9
    s_lshl_b32 s62, s60, 10
    s_add_u32 s62, s62, 159360
    v_add_u32 v19, s62, v9
    s_mov_b32 s62, 0xbfb8aa3b
    s_waitcnt lgkmcnt(6)
    v_lshlrev_b32 v152, 16, v120
    v_and_b32 v153, 0xffff0000, v120
    v_lshlrev_b32 v154, 16, v121
    v_and_b32 v155, 0xffff0000, v121
    v_lshlrev_b32 v156, 16, v122
    v_and_b32 v157, 0xffff0000, v122
    v_lshlrev_b32 v158, 16, v123
    v_and_b32 v159, 0xffff0000, v123
    v_lshlrev_b32 v160, 16, v124
    v_and_b32 v161, 0xffff0000, v124
    v_lshlrev_b32 v162, 16, v125
    v_and_b32 v163, 0xffff0000, v125
    v_lshlrev_b32 v164, 16, v126
    v_and_b32 v165, 0xffff0000, v126
    v_lshlrev_b32 v166, 16, v127
    v_and_b32 v167, 0xffff0000, v127
    v_mul_f32 v152, s62, v152
    v_mul_f32 v153, s62, v153
    v_mul_f32 v154, s62, v154
    v_mul_f32 v155, s62, v155
    v_mul_f32 v156, s62, v156
    v_mul_f32 v157, s62, v157
    v_mul_f32 v158, s62, v158
    v_mul_f32 v159, s62, v159
    v_mul_f32 v160, s62, v160
    v_mul_f32 v161, s62, v161
    v_mul_f32 v162, s62, v162
    v_mul_f32 v163, s62, v163
    v_mul_f32 v164, s62, v164
    v_mul_f32 v165, s62, v165
    v_mul_f32 v166, s62, v166
    v_mul_f32 v167, s62, v167
    v_cvt_pk_bf16_f32 v120, v152, v153
    v_cvt_pk_bf16_f32 v121, v154, v155
    v_cvt_pk_bf16_f32 v122, v156, v157
    v_cvt_pk_bf16_f32 v123, v158, v159
    v_cvt_pk_bf16_f32 v124, v160, v161
    v_cvt_pk_bf16_f32 v125, v162, v163
    v_cvt_pk_bf16_f32 v126, v164, v165
    v_cvt_pk_bf16_f32 v127, v166, v167
    ds_write_b128 v17, v[120:123]
    ds_write_b128 v19, v[124:127]
    s_waitcnt lgkmcnt(2)
    ds_write_b128 v17, v[128:131] offset:8192
    ds_write_b128 v18, v[132:135]
    ds_write_b128 v18, v[136:139] offset:8192
    s_cmp_lg_u32 s48, 7
    s_cbranch_scc1 NW7
    s_waitcnt vmcnt(4)
NW7:
    s_waitcnt lgkmcnt(0)
    s_barrier
    s_lshr_b32 s60, s48, 1
    s_and_b32 s61, s48, 1
    s_lshl_b32 s62, s60, 12
    s_add_u32 s62, s62, 67712
    v_add_u32 v30, s62, v8
    v_xor_b32 v31, 64, v30
    s_lshl_b32 s62, s61, 12
    s_add_u32 s62, s62, 84096
    v_add_u32 v29, s62, v9
    ds_read_b128 v[184:187], v30 offset:0
    ds_read_b128 v[188:191], v31 offset:0
    ds_read_b128 v[192:195], v30 offset:1024
    ds_read_b128 v[196:199], v31 offset:1024
    ds_read_b128 v[152:155], v29 offset:0
    ds_read_b128 v[156:159], v29 offset:1024
    ds_read_b128 v[160:163], v29 offset:2048
    ds_read_b128 v[164:167], v29 offset:3072
    ds_read_b128 v[168:171], v29 offset:8192
    ds_read_b128 v[172:175], v29 offset:9216
    ds_read_b128 v[176:179], v29 offset:10240
    ds_read_b128 v[180:183], v29 offset:11264
    s_lshl_b32 s60, s48, 5
    v_add_u32 v28, s60, v1
    s_movk_i32 s61, 2176
    v_mul_u32_u24 v28, s61, v28
    s_waitcnt lgkmcnt(0)
    s_barrier
    s_lshr_b32 s60, s48, 1
    s_and_b32 s61, s48, 1
    s_mul_i32 s62, s60, 24576
    s_movk_i32 s63, 6144
    v_mad_u32_u24 v25, v11, s63, v6
    v_add_u32 v25, s62, v25
    s_lshl_b32 s62, s61, 7
    v_add_u32 v24, s62, v25
    v_add_u32 v25, s62, v24
    v_mfma_f32_16x16x32_bf16 v[120:123], v[184:187], v[152:155], 0
    v_mfma_f32_16x16x32_bf16 v[124:127], v[192:195], v[152:155], 0
    v_mfma_f32_16x16x32_bf16 v[128:131], v[184:187], v[160:163], 0
    v_mfma_f32_16x16x32_bf16 v[132:135], v[192:195], v[160:163], 0
    v_mfma_f32_16x16x32_bf16 v[120:123], v[188:191], v[156:159], v[120:123]
    v_mfma_f32_16x16x32_bf16 v[124:127], v[196:199], v[156:159], v[124:127]
    v_mfma_f32_16x16x32_bf16 v[128:131], v[188:191], v[164:167], v[128:131]
    v_mfma_f32_16x16x32_bf16 v[132:135], v[196:199], v[164:167], v[132:135]
    v_mfma_f32_16x16x32_bf16 v[136:139], v[184:187], v[168:171], 0
    v_mfma_f32_16x16x32_bf16 v[140:143], v[192:195], v[168:171], 0
    v_mfma_f32_16x16x32_bf16 v[144:147], v[184:187], v[176:179], 0
    v_mfma_f32_16x16x32_bf16 v[148:151], v[192:195], v[176:179], 0
    v_mfma_f32_16x16x32_bf16 v[136:139], v[188:191], v[172:175], v[136:139]
    v_mfma_f32_16x16x32_bf16 v[140:143], v[196:199], v[172:175], v[140:143]
    v_mfma_f32_16x16x32_bf16 v[144:147], v[188:191], v[180:183], v[144:147]
    v_mfma_f32_16x16x32_bf16 v[148:151], v[196:199], v[180:183], v[148:151]
    s_lshl_b32 s62, s57, 3
    s_mov_b32 exec_hi, 0
    buffer_load_dwordx2 v[104:105], v28, s[36:39], s62 offen sc1
    s_mov_b32 exec_hi, -1
    s_cmp_lt_u32 s48, 6
    s_cbranch_scc1 PU_FULLA
    s_mov_b64 exec, 0xffff
PU_FULLA:
    s_mov_b32 s62, 0xbfb8aa3b
    v_mul_f32 v120, s62, v120
    v_mul_f32 v128, s62, v128
    v_and_b32 v154, 0xffff0000, v120
    v_and_b32 v155, 0xffff0000, v128
    v_sub_f32 v120, v120, v154
    v_sub_f32 v128, v128, v155
    v_cvt_pk_bf16_f32 v152, v154, v120
    v_cvt_pk_bf16_f32 v153, v155, v128
    ds_write_b64 v24, v[152:153] offset:512
    v_mul_f32 v124, s62, v124
    v_mul_f32 v132, s62, v132
    v_and_b32 v158, 0xffff0000, v124
    v_and_b32 v159, 0xffff0000, v132
    v_sub_f32 v124, v124, v158
    v_sub_f32 v132, v132, v159
    v_cvt_pk_bf16_f32 v156, v158, v124
    v_cvt_pk_bf16_f32 v157, v159, v132
    ds_write_b64 v24, v[156:157] offset:1280
    v_cvt_f64_f32 v[160:161], v136
    v_cvt_f64_f32 v[162:163], v144
    ds_write_b64 v25, v[160:161] offset:0
    ds_write_b64 v25, v[162:163] offset:128
    v_cvt_f64_f32 v[164:165], v140
    v_cvt_f64_f32 v[166:167], v148
    ds_write_b64 v25, v[164:165] offset:768
    ds_write_b64 v25, v[166:167] offset:896
    s_cmp_ge_u32 s48, 6
    s_cbranch_scc1 PU_DONEA
    v_mul_f32 v121, s62, v121
    v_mul_f32 v129, s62, v129
    v_and_b32 v170, 0xffff0000, v121
    v_and_b32 v171, 0xffff0000, v129
    v_sub_f32 v121, v121, v170
    v_sub_f32 v129, v129, v171
    v_cvt_pk_bf16_f32 v168, v170, v121
    v_cvt_pk_bf16_f32 v169, v171, v129
    ds_write_b64 v24, v[168:169] offset:3584
    v_mul_f32 v125, s62, v125
    v_mul_f32 v133, s62, v133
    v_and_b32 v174, 0xffff0000, v125
    v_and_b32 v175, 0xffff0000, v133
    v_sub_f32 v125, v125, v174
    v_sub_f32 v133, v133, v175
    v_cvt_pk_bf16_f32 v172, v174, v125
    v_cvt_pk_bf16_f32 v173, v175, v133
    ds_write_b64 v24, v[172:173] offset:4352
    v_cvt_f64_f32 v[176:177], v137
    v_cvt_f64_f32 v[178:179], v145
    ds_write_b64 v25, v[176:177] offset:3072
    ds_write_b64 v25, v[178:179] offset:3200
    v_cvt_f64_f32 v[180:181], v141
    v_cvt_f64_f32 v[182:183], v149
    ds_write_b64 v25, v[180:181] offset:3840
    ds_write_b64 v25, v[182:183] offset:3968
PU_DONEA:
    s_mov_b64 exec, -1
    s_mov_b32 s4, 1
    s_movk_i32 s5, 512
TPW:
    v_mov_b32 v20, 0
    v_mov_b32 v21, 0
    v_mov_b32 v22, 0
    v_mov_b32 v23, 0
    v_add_u32 v26, s3, v9
    ds_write_b128 v26, v[20:23] offset:2048
    v_lshl_add_u32 v26, v1, 2, s3
    v_lshlrev_b32 v18, 1, v1
    v_add_u32 v19, 1, v18
    v_add_u32 v27, -512, v18
    v_lshlrev_b32 v23, 27, v1
    s_add_u32 s61, s53, s54
    s_add_u32 s63, s53, 512
    s_mul_i32 s60, s48, 823296
    s_mul_i32 s64, s48, 102400
    v_mov_b32 v29, s64
    s_movk_i32 s64, 3200
    s_movk_i32 s65, 3216
    s_waitcnt vmcnt(0)
    s_mov_b32 exec_hi, 0
    v_xor_b32 v20, v104, v105
    v_cmp_ne_u32 vcc, s8, v20
    v_lshrrev_b32 v17, 16, v104
    v_min_u32 v20, s61, v17
    v_max_u32 v20, s53, v20
    v_subrev_u32 v20, s53, v20
    v_add_u32 v21, 1, v20
    v_and_b32 v21, -2, v21
    v_mov_b32 v22, v21
    s_cbranch_vccnz TAGAIN
TOK:
    s_nop 1
    v_add_u32_dpp v22, v22, v22 row_shr:1 row_mask:0xf bank_mask:0xf
    s_nop 1
    v_add_u32_dpp v22, v22, v22 row_shr:2 row_mask:0xf bank_mask:0xf
    s_nop 1
    v_add_u32_dpp v22, v22, v22 row_shr:4 row_mask:0xf bank_mask:0xf
    s_nop 1
    v_add_u32_dpp v22, v22, v22 row_shr:8 row_mask:0xf bank_mask:0xf
    s_nop 1
    v_add_u32_dpp v22, v22, v22 row_bcast:15 row_mask:0xa bank_mask:0xf
    v_and_b32 v16, 0xffff, v104
    v_readlane_b32 s62, v22, 31
    v_sub_u32 v22, v22, v21
    v_add_u32 v20, v22, v20
    v_min_u32 v20, 0x7ff, v20
    v_sub_u32 v16, v16, v22
    v_add_lshl_u32 v16, v16, s63, 11
    v_or3_b32 v16, v16, v23, v20
    v_cmp_lt_u32 vcc, v22, v20
    v_cmp_gt_u32 s[66:67], s5, v22
    v_lshl_add_u32 v22, v22, 1, s3
    s_and_b64 exec, vcc, s[66:67]
    ds_write_b32 v22, v16 offset:2048
    s_mov_b64 exec, -1
    ds_read_b32 v96, v26 offset:2048
    ds_read_b32 v97, v26 offset:2304
    ds_read_b32 v98, v26 offset:2560
    ds_read_b32 v99, v26 offset:2816
    s_cmp_gt_u32 s62, 512
    s_cbranch_scc1 XMAX
    s_cmp_lg_u32 s54, 4096
    s_cbranch_scc1 XMAX
XBACK:
    s_waitcnt lgkmcnt(0)
    v_max_u32_dpp v96, v96, v96 row_shr:1 row_mask:0xf bank_mask:0xf
    v_max_u32_dpp v97, v97, v97 row_shr:1 row_mask:0xf bank_mask:0xf
    v_max_u32_dpp v98, v98, v98 row_shr:1 row_mask:0xf bank_mask:0xf
    v_max_u32_dpp v99, v99, v99 row_shr:1 row_mask:0xf bank_mask:0xf
    v_max_u32_dpp v96, v96, v96 row_shr:2 row_mask:0xf bank_mask:0xf
    v_max_u32_dpp v97, v97, v97 row_shr:2 row_mask:0xf bank_mask:0xf
    v_max_u32_dpp v98, v98, v98 row_shr:2 row_mask:0xf bank_mask:0xf
    v_max_u32_dpp v99, v99, v99 row_shr:2 row_mask:0xf bank_mask:0xf
    v_max_u32_dpp v96, v96, v96 row_shr:4 row_mask:0xf bank_mask:0xf
    v_max_u32_dpp v97, v97, v97 row_shr:4 row_mask:0xf bank_mask:0xf
    v_max_u32_dpp v98, v98, v98 row_shr:4 row_mask:0xf bank_mask:0xf
    v_max_u32_dpp v99, v99, v99 row_shr:4 row_mask:0xf bank_mask:0xf
    v_max_u32_dpp v96, v96, v96 row_shr:8 row_mask:0xf bank_mask:0xf
    v_max_u32_dpp v97, v97, v97 row_shr:8 row_mask:0xf bank_mask:0xf
    v_max_u32_dpp v98, v98, v98 row_shr:8 row_mask:0xf bank_mask:0xf
    v_max_u32_dpp v99, v99, v99 row_shr:8 row_mask:0xf bank_mask:0xf
    v_max_u32_dpp v96, v96, v96 row_bcast:15 row_mask:0xa bank_mask:0xf
    v_max_u32_dpp v97, v97, v97 row_bcast:15 row_mask:0xa bank_mask:0xf
    v_max_u32_dpp v98, v98, v98 row_bcast:15 row_mask:0xa bank_mask:0xf
    v_max_u32_dpp v99, v99, v99 row_bcast:15 row_mask:0xa bank_mask:0xf
    v_max_u32_dpp v96, v96, v96 row_bcast:31 row_mask:0xc bank_mask:0xf
    v_max_u32_dpp v97, v97, v97 row_bcast:31 row_mask:0xc bank_mask:0xf
    v_max_u32_dpp v98, v98, v98 row_bcast:31 row_mask:0xc bank_mask:0xf
    v_max_u32_dpp v99, v99, v99 row_bcast:31 row_mask:0xc bank_mask:0xf
    v_readlane_b32 s62, v96, 63
    v_and_b32 v20, 0x7ff, v96
    v_lshrrev_b32 v21, 27, v96
    v_bfe_u32 v22, v96, 11, 13
    v_max_u32 v97, s62, v97
    v_cmp_lt_i32 s[68:69], v18, v20
    v_cmp_lt_i32 s[70:71], v19, v20
    v_mad_u32_u24 v22, v21, s65, v22
    v_add_lshl_u32 v22, v22, v27, 3
    v_mad_u32_u24 v184, v21, s64, v29
    s_and_b64 exec, s[68:69], -1
    s_cbranch_scc0 RS0
    buffer_load_dwordx4 v[32:35], v22, s[32:35], s60 offen offset:0 sc1
RS0:
    s_mov_b64 exec, -1
    v_readlane_b32 s62, v97, 63
    v_and_b32 v20, 0x7ff, v97
    v_lshrrev_b32 v21, 27, v97
    v_subrev_u32 v20, 128, v20
    v_bfe_u32 v22, v97, 11, 13
    v_max_u32 v98, s62, v98
    v_cmp_lt_i32 s[72:73], v18, v20
    v_cmp_lt_i32 s[74:75], v19, v20
    v_mad_u32_u24 v22, v21, s65, v22
    v_add_lshl_u32 v22, v22, v27, 3
    v_mad_u32_u24 v185, v21, s64, v29
    s_and_b64 exec, s[72:73], -1
    s_cbranch_scc0 RS1
    buffer_load_dwordx4 v[36:39], v22, s[32:35], s60 offen offset:1024 sc1
RS1:
    s_mov_b64 exec, -1
    v_readlane_b32 s62, v98, 63
    v_and_b32 v20, 0x7ff, v98
    v_lshrrev_b32 v21, 27, v98
    v_subrev_u32 v20, 256, v20
    v_bfe_u32 v22, v98, 11, 13
    v_max_u32 v99, s62, v99
    v_cmp_lt_i32 s[76:77], v18, v20
    v_cmp_lt_i32 s[78:79], v19, v20
    v_mad_u32_u24 v22, v21, s65, v22
    v_add_lshl_u32 v22, v22, v27, 3
    v_mad_u32_u24 v186, v21, s64, v29
    s_and_b64 exec, s[76:77], -1
    s_cbranch_scc0 RS2
    buffer_load_dwordx4 v[40:43], v22, s[32:35], s60 offen offset:2048 sc1
RS2:
    s_mov_b64 exec, -1
    v_and_b32 v20, 0x7ff, v99
    v_lshrrev_b32 v21, 27, v99
    v_subrev_u32 v20, 384, v20
    v_bfe_u32 v22, v99, 11, 13
    v_cmp_lt_i32 s[80:81], v18, v20
    v_cmp_lt_i32 s[82:83], v19, v20
    v_mad_u32_u24 v22, v21, s65, v22
    v_add_lshl_u32 v22, v22, v27, 3
    v_mad_u32_u24 v187, v21, s64, v29
    s_and_b64 exec, s[80:81], -1
    s_cbranch_scc0 RS3
    buffer_load_dwordx4 v[44:47], v22, s[32:35], s60 offen offset:3072 sc1
RS3:
    s_mov_b64 exec, -1
    s_cmp_eq_u32 s4, 0
    s_cbranch_scc1 NOPU2
    s_mov_b32 s4, 0
    s_mov_b32 s62, 0xbfb8aa3b
    s_cmp_ge_u32 s48, 6
    s_cbranch_scc1 PU_DONEC
    v_mul_f32 v122, s62, v122
    v_mul_f32 v130, s62, v130
    v_and_b32 v154, 0xffff0000, v122
    v_and_b32 v155, 0xffff0000, v130
    v_sub_f32 v122, v122, v154
    v_sub_f32 v130, v130, v155
    v_cvt_pk_bf16_f32 v152, v154, v122
    v_cvt_pk_bf16_f32 v153, v155, v130
    ds_write_b64 v24, v[152:153] offset:2048
    v_mul_f32 v126, s62, v126
    v_mul_f32 v134, s62, v134
    v_and_b32 v158, 0xffff0000, v126
    v_and_b32 v159, 0xffff0000, v134
    v_sub_f32 v126, v126, v158
    v_sub_f32 v134, v134, v159
    v_cvt_pk_bf16_f32 v156, v158, v126
    v_cvt_pk_bf16_f32 v157, v159, v134
    ds_write_b64 v24, v[156:157] offset:2816
    v_cvt_f64_f32 v[160:161], v138
    v_cvt_f64_f32 v[162:163], v146
    ds_write_b64 v25, v[160:161] offset:1536
    ds_write_b64 v25, v[162:163] offset:1664
    v_cvt_f64_f32 v[164:165], v142
    v_cvt_f64_f32 v[166:167], v150
    ds_write_b64 v25, v[164:165] offset:2304
    ds_write_b64 v25, v[166:167] offset:2432
    v_mul_f32 v123, s62, v123
    v_mul_f32 v131, s62, v131
    v_and_b32 v170, 0xffff0000, v123
    v_and_b32 v171, 0xffff0000, v131
    v_sub_f32 v123, v123, v170
    v_sub_f32 v131, v131, v171
    v_cvt_pk_bf16_f32 v168, v170, v123
    v_cvt_pk_bf16_f32 v169, v171, v131
    ds_write_b64 v24, v[168:169] offset:5120
    v_mul_f32 v127, s62, v127
    v_mul_f32 v135, s62, v135
    v_and_b32 v174, 0xffff0000, v127
    v_and_b32 v175, 0xffff0000, v135
    v_sub_f32 v127, v127, v174
    v_sub_f32 v135, v135, v175
    v_cvt_pk_bf16_f32 v172, v174, v127
    v_cvt_pk_bf16_f32 v173, v175, v135
    ds_write_b64 v24, v[172:173] offset:5888
    v_cvt_f64_f32 v[176:177], v139
    v_cvt_f64_f32 v[178:179], v147
    ds_write_b64 v25, v[176:177] offset:4608
    ds_write_b64 v25, v[178:179] offset:4736
    v_cvt_f64_f32 v[180:181], v143
    v_cvt_f64_f32 v[182:183], v151
    ds_write_b64 v25, v[180:181] offset:5376
    ds_write_b64 v25, v[182:183] offset:5504
PU_DONEC:
    s_mov_b64 exec, -1
NOPU2:
    v_mov_b32 v31, 16
    v_mov_b32 v30, 1
    v_mov_b32 v17, 0
    v_mov_b32 v16, 0
    v_mov_b32 v29, 0x7fc
    s_waitcnt vmcnt(0)
    s_mov_b64 exec, s[68:69]
    v_bitop3_b32 v17, v32, s59, v17 bitop3:0xbe
    v_bitop3_b32 v16, v33, s21, v16 bitop3:0xbe
    s_mov_b64 exec, s[70:71]
    v_bitop3_b32 v17, v34, s59, v17 bitop3:0xbe
    v_bitop3_b32 v16, v35, s21, v16 bitop3:0xbe
    s_mov_b64 exec, s[72:73]
    v_bitop3_b32 v17, v36, s59, v17 bitop3:0xbe
    v_bitop3_b32 v16, v37, s21, v16 bitop3:0xbe
    s_mov_b64 exec, s[74:75]
    v_bitop3_b32 v17, v38, s59, v17 bitop3:0xbe
    v_bitop3_b32 v16, v39, s21, v16 bitop3:0xbe
    s_mov_b64 exec, s[76:77]
    v_bitop3_b32 v17, v40, s59, v17 bitop3:0xbe
    v_bitop3_b32 v16, v41, s21, v16 bitop3:0xbe
    s_mov_b64 exec, s[78:79]
    v_bitop3_b32 v17, v42, s59, v17 bitop3:0xbe
    v_bitop3_b32 v16, v43, s21, v16 bitop3:0xbe
    s_mov_b64 exec, s[80:81]
    v_bitop3_b32 v17, v44, s59, v17 bitop3:0xbe
    v_bitop3_b32 v16, v45, s21, v16 bitop3:0xbe
    s_mov_b64 exec, s[82:83]
    v_bitop3_b32 v17, v46, s59, v17 bitop3:0xbe
    v_bitop3_b32 v16, v47, s21, v16 bitop3:0xbe
    s_mov_b64 exec, -1
    s_mov_b32 s61, 0xf8030000
    v_and_or_b32 v17, v16, s61, v17
    v_cmp_le_u32 vcc, 0x1000, v17
    v_and_b32_sdwa v64, v33, v29 dst_sel:DWORD dst_unused:UNUSED_PAD src0_sel:WORD_1 src1_sel:DWORD
    v_and_b32_sdwa v65, v35, v29 dst_sel:DWORD dst_unused:UNUSED_PAD src0_sel:WORD_1 src1_sel:DWORD
    v_and_b32_sdwa v66, v37, v29 dst_sel:DWORD dst_unused:UNUSED_PAD src0_sel:WORD_1 src1_sel:DWORD
    v_and_b32_sdwa v67, v39, v29 dst_sel:DWORD dst_unused:UNUSED_PAD src0_sel:WORD_1 src1_sel:DWORD
    v_and_b32_sdwa v68, v41, v29 dst_sel:DWORD dst_unused:UNUSED_PAD src0_sel:WORD_1 src1_sel:DWORD
    v_and_b32_sdwa v69, v43, v29 dst_sel:DWORD dst_unused:UNUSED_PAD src0_sel:WORD_1 src1_sel:DWORD
    v_and_b32_sdwa v70, v45, v29 dst_sel:DWORD dst_unused:UNUSED_PAD src0_sel:WORD_1 src1_sel:DWORD
    v_and_b32_sdwa v71, v47, v29 dst_sel:DWORD dst_unused:UNUSED_PAD src0_sel:WORD_1 src1_sel:DWORD
    s_cbranch_vccnz RETRY
RGOOD:
    s_mov_b64 exec, s[68:69]
    ds_add_rtn_u32 v80, v64, v30 offset:128
    s_mov_b64 exec, s[70:71]
    ds_add_rtn_u32 v81, v65, v30 offset:128
    s_mov_b64 exec, s[72:73]
    ds_add_rtn_u32 v82, v66, v30 offset:128
    s_mov_b64 exec, s[74:75]
    ds_add_rtn_u32 v83, v67, v30 offset:128
    s_mov_b64 exec, s[76:77]
    ds_add_rtn_u32 v84, v68, v30 offset:128
    s_mov_b64 exec, s[78:79]
    ds_add_rtn_u32 v85, v69, v30 offset:128
    s_mov_b64 exec, s[80:81]
    ds_add_rtn_u32 v86, v70, v30 offset:128
    s_mov_b64 exec, s[82:83]
    ds_add_rtn_u32 v87, v71, v30 offset:128
    s_mov_b64 exec, -1
    v_xad_u32 v32, v32, s59, v184
    v_xad_u32 v34, v34, s59, v184
    v_xad_u32 v36, v36, s59, v185
    v_xad_u32 v38, v38, s59, v185
    v_xad_u32 v40, v40, s59, v186
    v_xad_u32 v42, v42, s59, v186
    v_xad_u32 v44, v44, s59, v187
    v_xad_u32 v46, v46, s59, v187
    v_mov_b32 v21, 6394
    v_cmp_lt_u32_sdwa vcc, v33, v21 src0_sel:WORD_0 src1_sel:DWORD
    s_and_b64 exec, vcc, s[68:69]
    s_cbranch_scc0 PS0
    buffer_load_dword v7, v32, s[28:31], 0 idxen
PS0:
    s_mov_b64 exec, -1
    v_cmp_lt_u32_sdwa vcc, v35, v21 src0_sel:WORD_0 src1_sel:DWORD
    s_and_b64 exec, vcc, s[70:71]
    s_cbranch_scc0 PS1
    buffer_load_dword v7, v34, s[28:31], 0 idxen
PS1:
    s_mov_b64 exec, -1
    v_cmp_lt_u32_sdwa vcc, v37, v21 src0_sel:WORD_0 src1_sel:DWORD
    s_and_b64 exec, vcc, s[72:73]
    s_cbranch_scc0 PS2
    buffer_load_dword v7, v36, s[28:31], 0 idxen
PS2:
    s_mov_b64 exec, -1
    v_and_b32 v33, 0x07f0ffff, v33
    v_bfe_u32 v136, v33, 18, 9
    v_and_b32 v35, 0x07f0ffff, v35
    v_bfe_u32 v137, v35, 18, 9
    v_and_b32 v37, 0x07f0ffff, v37
    v_bfe_u32 v138, v37, 18, 9
    v_and_b32 v39, 0x07f0ffff, v39
    v_bfe_u32 v139, v39, 18, 9
    v_and_b32 v41, 0x07f0ffff, v41
    v_bfe_u32 v140, v41, 18, 9
    v_and_b32 v43, 0x07f0ffff, v43
    v_bfe_u32 v141, v43, 18, 9
    v_and_b32 v45, 0x07f0ffff, v45
    v_bfe_u32 v142, v45, 18, 9
    v_and_b32 v47, 0x07f0ffff, v47
    v_bfe_u32 v143, v47, 18, 9
    v_lshlrev_b32 v29, 5, v1
    s_lshl_b32 s61, s10, 2
    s_waitcnt lgkmcnt(0)
    s_barrier
    ds_read_b128 v[202:205], v29 offset:128
    ds_read_b128 v[208:211], v29 offset:144
    ds_read_b64 v[30:31], v31
    s_waitcnt lgkmcnt(1)
    v_add_u32 v222, v202, v203
    v_add_u32 v223, v222, v204
    v_add3_u32 v16, v223, v205, 3
    v_and_b32 v16, -4, v16
    v_max_u32 v16, s61, v16
    v_subrev_u32 v16, s61, v16
    v_add_u32 v226, v208, v209
    v_add_u32 v227, v226, v210
    v_add3_u32 v17, v227, v211, 3
    v_and_b32 v17, -4, v17
    v_max_u32 v17, s61, v17
    v_subrev_u32 v17, s61, v17
    s_mul_i32 s62, s61, 97
    v_add_u32 v18, v16, v17
    s_nop 1
    v_add_u32_dpp v18, v18, v18 row_shr:1 row_mask:0xf bank_mask:0xf
    s_nop 1
    v_add_u32_dpp v18, v18, v18 row_shr:2 row_mask:0xf bank_mask:0xf
    s_nop 1
    v_add_u32_dpp v18, v18, v18 row_shr:4 row_mask:0xf bank_mask:0xf
    s_nop 1
    v_add_u32_dpp v18, v18, v18 row_shr:8 row_mask:0xf bank_mask:0xf
    s_nop 1
    v_add_u32_dpp v18, v18, v18 row_bcast:15 row_mask:0xa bank_mask:0xf
    s_nop 1
    v_add_u32_dpp v18, v18, v18 row_bcast:31 row_mask:0xc bank_mask:0xf
    s_waitcnt lgkmcnt(0)
    v_readfirstlane_b32 s56, v30
    v_readfirstlane_b32 s64, v31
    v_readlane_b32 s63, v18, 63
    v_sub_u32 v27, v18, v17
    v_sub_u32 v26, v27, v16
    v_add_lshl_u32 v220, v26, s62, 16
    v_add_lshl_u32 v224, v27, s62, 16
    v_add_u32 v221, v220, v202
    v_add_u32 v225, v224, v208
    v_add_u32 v222, v220, v222
    v_add_u32 v226, v224, v226
    v_add_u32 v223, v220, v223
    v_add_u32 v227, v224, v227
    ds_write_b128 v29, v[220:223] offset:34944
    ds_write_b128 v29, v[224:227] offset:34960
    s_add_u32 s62, s62, s61
    s_add_u32 s63, s63, s62
    s_cmp_gt_u32 s63, 3584
    s_cbranch_scc1 NOFIT
    s_cmp_gt_u32 s64, 512
    s_cbranch_scc1 NOFIT
    ds_read_b32 v64, v64 offset:34944
    ds_read_b32 v65, v65 offset:34944
    ds_read_b32 v66, v66 offset:34944
    ds_read_b32 v67, v67 offset:34944
    ds_read_b32 v68, v68 offset:34944
    ds_read_b32 v69, v69 offset:34944
    ds_read_b32 v70, v70 offset:34944
    ds_read_b32 v71, v71 offset:34944
    s_add_u32 s63, s63, 31
    s_lshr_b32 s63, s63, 5
    s_add_u32 s63, s63, 7
    s_sub_u32 s63, s63, s48
    s_lshr_b32 s51, s63, 3
    s_movk_i32 s60, 97
    s_waitcnt lgkmcnt(4)
    v_add_u32_sdwa v80, v64, v80 dst_sel:DWORD dst_unused:UNUSED_PAD src0_sel:WORD_0 src1_sel:DWORD
    v_lshrrev_b32 v64, 16, v64
    v_cmp_gt_u32 vcc, s61, v80
    v_and_b32 v29, -4, v80
    v_mad_u32_u24 v29, v29, s60, v136
    v_cndmask_b32 v64, v64, v29, vcc
    v_add_lshl_u32 v64, v64, v80, 3
    v_add_u32_sdwa v81, v65, v81 dst_sel:DWORD dst_unused:UNUSED_PAD src0_sel:WORD_0 src1_sel:DWORD
    v_lshrrev_b32 v65, 16, v65
    v_cmp_gt_u32 vcc, s61, v81
    v_and_b32 v29, -4, v81
    v_mad_u32_u24 v29, v29, s60, v137
    v_cndmask_b32 v65, v65, v29, vcc
    v_add_lshl_u32 v65, v65, v81, 3
    v_add_u32_sdwa v82, v66, v82 dst_sel:DWORD dst_unused:UNUSED_PAD src0_sel:WORD_0 src1_sel:DWORD
    v_lshrrev_b32 v66, 16, v66
    v_cmp_gt_u32 vcc, s61, v82
    v_and_b32 v29, -4, v82
    v_mad_u32_u24 v29, v29, s60, v138
    v_cndmask_b32 v66, v66, v29, vcc
    v_add_lshl_u32 v66, v66, v82, 3
    v_add_u32_sdwa v83, v67, v83 dst_sel:DWORD dst_unused:UNUSED_PAD src0_sel:WORD_0 src1_sel:DWORD
    v_lshrrev_b32 v67, 16, v67
    v_cmp_gt_u32 vcc, s61, v83
    v_and_b32 v29, -4, v83
    v_mad_u32_u24 v29, v29, s60, v139
    v_cndmask_b32 v67, v67, v29, vcc
    v_add_lshl_u32 v67, v67, v83, 3
    s_waitcnt lgkmcnt(0)
    v_add_u32_sdwa v84, v68, v84 dst_sel:DWORD dst_unused:UNUSED_PAD src0_sel:WORD_0 src1_sel:DWORD
    v_lshrrev_b32 v68, 16, v68
    v_cmp_gt_u32 vcc, s61, v84
    v_and_b32 v29, -4, v84
    v_mad_u32_u24 v29, v29, s60, v140
    v_cndmask_b32 v68, v68, v29, vcc
    v_add_lshl_u32 v68, v68, v84, 3
    v_add_u32_sdwa v85, v69, v85 dst_sel:DWORD dst_unused:UNUSED_PAD src0_sel:WORD_0 src1_sel:DWORD
    v_lshrrev_b32 v69, 16, v69
    v_cmp_gt_u32 vcc, s61, v85
    v_and_b32 v29, -4, v85
    v_mad_u32_u24 v29, v29, s60, v141
    v_cndmask_b32 v69, v69, v29, vcc
    v_add_lshl_u32 v69, v69, v85, 3
    v_add_u32_sdwa v86, v70, v86 dst_sel:DWORD dst_unused:UNUSED_PAD src0_sel:WORD_0 src1_sel:DWORD
    v_lshrrev_b32 v70, 16, v70
    v_cmp_gt_u32 vcc, s61, v86
    v_and_b32 v29, -4, v86
    v_mad_u32_u24 v29, v29, s60, v142
    v_cndmask_b32 v70, v70, v29, vcc
    v_add_lshl_u32 v70, v70, v86, 3
    v_add_u32_sdwa v87, v71, v87 dst_sel:DWORD dst_unused:UNUSED_PAD src0_sel:WORD_0 src1_sel:DWORD
    v_lshrrev_b32 v71, 16, v71
    v_cmp_gt_u32 vcc, s61, v87
    v_and_b32 v29, -4, v87
    v_mad_u32_u24 v29, v29, s60, v143
    v_cndmask_b32 v71, v71, v29, vcc
    v_add_lshl_u32 v71, v71, v87, 3
    s_mov_b64 exec, s[68:69]
    ds_write_b64 v64, v[32:33] offset:2176
    s_mov_b64 exec, s[70:71]
    ds_write_b64 v65, v[34:35] offset:2176
    s_mov_b64 exec, s[72:73]
    ds_write_b64 v66, v[36:37] offset:2176
    s_mov_b64 exec, s[74:75]
    ds_write_b64 v67, v[38:39] offset:2176
    s_mov_b64 exec, s[76:77]
    ds_write_b64 v68, v[40:41] offset:2176
    s_mov_b64 exec, s[78:79]
    ds_write_b64 v69, v[42:43] offset:2176
    s_mov_b64 exec, s[80:81]
    ds_write_b64 v70, v[44:45] offset:2176
    s_mov_b64 exec, s[82:83]
    ds_write_b64 v71, v[46:47] offset:2176
    s_mov_b64 exec, -1
    v_add_u32 v30, 142976, v9
    s_waitcnt lgkmcnt(0)
    s_barrier
    s_cmp_eq_u32 s51, 0
    s_cbranch_scc1 MAIN_DONE
    ds_read_b32 v248, v3 offset:2176
    ds_read_b128 v[236:239], v2 offset:2176
    ds_read_b128 v[240:243], v2 offset:2192
    ds_read_b32 v20, v3 offset:4224
    ds_read_u16 v16, v4 offset:2182
    ds_read_u16 v17, v4 offset:2214
    s_waitcnt lgkmcnt(5)
    buffer_load_dwordx4 v[202:205], v[248:249], s[28:31], 0 idxen offen
    s_waitcnt lgkmcnt(3)
    v_mad_u32_u16 v236, v237, s55, v250
    v_mad_u32_u16 v238, v239, s55, v251
    v_mad_u32_u16 v240, v241, s55, v252
    v_mad_u32_u16 v242, v243, s55, v253
    buffer_load_dwordx4 v236, s[24:27], 0 offen offset:0 lds
    buffer_load_dwordx4 v238, s[24:27], 0 offen offset:1024 lds
    buffer_load_dwordx4 v240, s[24:27], 0 offen offset:2048 lds
    buffer_load_dwordx4 v242, s[24:27], 0 offen offset:3072 lds
    s_waitcnt lgkmcnt(0)
    v_mov_b32 v248, v20
    v_mad_u32_u24 v22, v16, s11, v6
    v_mad_u32_u24 v23, v17, s11, v6
    ds_read_b128 v[236:239], v2 offset:4224
    ds_read_b128 v[240:243], v2 offset:4240
    ds_read_b128 v[32:35], v30 offset:0
    ds_read_b128 v[36:39], v30 offset:1024
    ds_read_b128 v[40:43], v30 offset:2048
    ds_read_b128 v[44:47], v30 offset:3072
    ds_read_b128 v[48:51], v30 offset:4096
    ds_read_b128 v[52:55], v30 offset:5120
    ds_read_b128 v[56:59], v30 offset:6144
    ds_read_b128 v[60:63], v30 offset:7168
    ds_read_b128 v[64:67], v30 offset:8192
    ds_read_b128 v[68:71], v30 offset:9216
    ds_read_b128 v[72:75], v30 offset:10240
    ds_read_b128 v[76:79], v30 offset:11264
    ds_read_b128 v[80:83], v30 offset:12288
    ds_read_b128 v[84:87], v30 offset:13312
    ds_read_b128 v[88:91], v30 offset:14336
    ds_read_b128 v[92:95], v30 offset:15360
    buffer_load_dwordx4 v[208:211], v[248:249], s[28:31], 0 idxen offen
    ds_read_b32 v248, v3 offset:6272
    ds_read_b64 v[96:97], v30 offset:16384
    ds_read_b64 v[100:101], v30 offset:16384
    ds_read_b64 v[102:103], v30 offset:16392
    ds_read_b64 v[106:107], v30 offset:16392
    ds_read_b64 v[108:109], v30 offset:17408
    ds_read_b64 v[112:113], v30 offset:17408
    ds_read_b64 v[114:115], v30 offset:17416
    ds_read_b64 v[118:119], v30 offset:17416
    ds_read_b32 v98, v22 offset:512
    ds_read_b32 v99, v23 offset:512
    ds_read_b32 v104, v22 offset:516
    ds_read_b32 v105, v23 offset:516
    ds_read_b32 v110, v22 offset:640
    ds_read_b32 v111, v23 offset:640
    ds_read_b32 v116, v22 offset:644
    ds_read_b32 v117, v23 offset:644
    s_waitcnt lgkmcnt(12)
    v_mad_u32_u16 v236, v237, s55, v250
    v_mad_u32_u16 v238, v239, s55, v251
    v_mad_u32_u16 v240, v241, s55, v252
    v_mad_u32_u16 v242, v243, s55, v253
    s_waitcnt vmcnt(1)
    ds_read_b128 v[184:187], v12 offset:0
    ds_read_b128 v[188:191], v13 offset:0
    ds_read_b128 v[192:195], v12 offset:1024
    ds_read_b128 v[196:199], v13 offset:1024
    v_permlane16_swap_b32 v202, v204
    v_permlane16_swap_b32 v203, v205
    s_waitcnt lgkmcnt(0)
    buffer_load_dwordx4 v236, s[24:27], 0 offen offset:0 lds
    buffer_load_dwordx4 v238, s[24:27], 0 offen offset:1024 lds
    buffer_load_dwordx4 v240, s[24:27], 0 offen offset:2048 lds
    buffer_load_dwordx4 v242, s[24:27], 0 offen offset:3072 lds
    s_cmp_lg_u32 s52, 0
    s_cbranch_scc1 MAIN_SAFE
    v_mov_b32 v244, 0
    v_mov_b32 v245, 0
    v_mov_b32 v246, 0
    v_mov_b32 v247, 0
    v_mov_b32 v26, v22
    v_mov_b32 v27, v23
    s_setprio 1
    v_mfma_f32_16x16x32_bf16 v[120:123], v[200:203], v[98:101], 0
    v_mfma_f32_16x16x32_bf16 v[120:123], v[184:187], v[32:35], v[120:123]
    v_mfma_f32_16x16x32_bf16 v[120:123], v[188:191], v[36:39], v[120:123]
    v_mfma_f32_16x16x32_bf16 v[124:127], v[204:207], v[96:99], 0
    v_mfma_f32_16x16x32_bf16 v[124:127], v[192:195], v[32:35], v[124:127]
    v_mfma_f32_16x16x32_bf16 v[124:127], v[196:199], v[36:39], v[124:127]
    v_mfma_f32_16x16x32_bf16 v[128:131], v[200:203], v[104:107], 0
    v_mfma_f32_16x16x32_bf16 v[128:131], v[184:187], v[40:43], v[128:131]
    v_mfma_f32_16x16x32_bf16 v[128:131], v[188:191], v[44:47], v[128:131]
    v_mfma_f32_16x16x32_bf16 v[132:135], v[204:207], v[102:105], 0
    v_mfma_f32_16x16x32_bf16 v[132:135], v[192:195], v[40:43], v[132:135]
    v_mfma_f32_16x16x32_bf16 v[132:135], v[196:199], v[44:47], v[132:135]
    v_mfma_f32_16x16x32_bf16 v[152:155], v[184:187], v[64:67], 0
    v_mfma_f32_16x16x32_bf16 v[152:155], v[188:191], v[68:71], v[152:155]
    v_mfma_f32_16x16x32_bf16 v[156:159], v[192:195], v[64:67], 0
    v_mfma_f32_16x16x32_bf16 v[156:159], v[196:199], v[68:71], v[156:159]
    v_mfma_f32_16x16x32_bf16 v[160:163], v[184:187], v[72:75], 0
    v_mfma_f32_16x16x32_bf16 v[160:163], v[188:191], v[76:79], v[160:163]
    v_mfma_f32_16x16x32_bf16 v[164:167], v[192:195], v[72:75], 0
    v_mfma_f32_16x16x32_bf16 v[164:167], v[196:199], v[76:79], v[164:167]
    s_setprio 0
    buffer_load_dwordx4 v[214:217], v[248:249], s[28:31], 0 idxen offen
    ds_read_u16 v16, v4 offset:4230
    ds_read_u16 v17, v4 offset:4262
    ds_read_b128 v[236:239], v2 offset:6272
    ds_read_b128 v[240:243], v2 offset:6288
    s_waitcnt lgkmcnt(0)
    s_nop 7
    s_setprio 1
    v_mfma_f32_16x16x32_bf16 v[136:139], v[200:203], v[110:113], 0
    v_mad_u32_u24 v24, v16, s11, v6
    v_mad_u32_u24 v25, v17, s11, v6
    v_mfma_f32_16x16x32_bf16 v[136:139], v[184:187], v[48:51], v[136:139]
    v_mad_u32_u16 v236, v237, s55, v250
    v_mad_u32_u16 v238, v239, s55, v251
    v_mfma_f32_16x16x32_bf16 v[136:139], v[188:191], v[52:55], v[136:139]
    v_mad_u32_u16 v240, v241, s55, v252
    v_mad_u32_u16 v242, v243, s55, v253
    v_mfma_f32_16x16x32_bf16 v[140:143], v[204:207], v[108:111], 0
    v_exp_f32 v120, v120
    v_mfma_f32_16x16x32_bf16 v[140:143], v[192:195], v[48:51], v[140:143]
    v_exp_f32 v121, v121
    v_mfma_f32_16x16x32_bf16 v[140:143], v[196:199], v[52:55], v[140:143]
    v_exp_f32 v122, v122
    v_mfma_f32_16x16x32_bf16 v[144:147], v[200:203], v[116:119], 0
    v_exp_f32 v123, v123
    v_mfma_f32_16x16x32_bf16 v[144:147], v[184:187], v[56:59], v[144:147]
    v_exp_f32 v124, v124
    v_mfma_f32_16x16x32_bf16 v[144:147], v[188:191], v[60:63], v[144:147]
    v_exp_f32 v125, v125
    v_mfma_f32_16x16x32_bf16 v[148:151], v[204:207], v[114:117], 0
    v_exp_f32 v126, v126
    v_mfma_f32_16x16x32_bf16 v[148:151], v[192:195], v[56:59], v[148:151]
    v_exp_f32 v127, v127
    v_mfma_f32_16x16x32_bf16 v[148:151], v[196:199], v[60:63], v[148:151]
    v_exp_f32 v128, v128
    v_mfma_f32_16x16x32_bf16 v[168:171], v[184:187], v[80:83], 0
    v_exp_f32 v129, v129
    v_mfma_f32_16x16x32_bf16 v[168:171], v[188:191], v[84:87], v[168:171]
    v_exp_f32 v130, v130
    v_mfma_f32_16x16x32_bf16 v[172:175], v[192:195], v[80:83], 0
    v_exp_f32 v131, v131
    v_mfma_f32_16x16x32_bf16 v[172:175], v[196:199], v[84:87], v[172:175]
    v_exp_f32 v132, v132
    v_mfma_f32_16x16x32_bf16 v[176:179], v[184:187], v[88:91], 0
    v_exp_f32 v133, v133
    v_mfma_f32_16x16x32_bf16 v[176:179], v[188:191], v[92:95], v[176:179]
    v_exp_f32 v134, v134
    v_mfma_f32_16x16x32_bf16 v[180:183], v[192:195], v[88:91], 0
    v_exp_f32 v135, v135
    v_mfma_f32_16x16x32_bf16 v[180:183], v[196:199], v[92:95], v[180:183]
    s_setprio 0
    s_waitcnt vmcnt(1)
    ds_read_b128 v[184:187], v12 offset:0
    ds_read_b128 v[188:191], v13 offset:0
    ds_read_b128 v[192:195], v12 offset:1024
    ds_read_b128 v[196:199], v13 offset:1024
    ds_read_b32 v248, v3 offset:8320
    ds_read_b32 v98, v24 offset:512
    ds_read_b32 v99, v25 offset:512
    ds_read_b32 v104, v24 offset:516
    ds_read_b32 v105, v25 offset:516
    s_waitcnt lgkmcnt(5)
    buffer_load_dwordx4 v236, s[24:27], 0 offen offset:0 lds
    buffer_load_dwordx4 v238, s[24:27], 0 offen offset:1024 lds
    buffer_load_dwordx4 v240, s[24:27], 0 offen offset:2048 lds
    buffer_load_dwordx4 v242, s[24:27], 0 offen offset:3072 lds
    s_sub_u32 s51, s51, 1
    s_cmp_eq_u32 s51, 0
    s_waitcnt lgkmcnt(0)
    v_permlane16_swap_b32 v208, v210
    v_permlane16_swap_b32 v209, v211
    v_pk_add_f32 v[224:225], v[120:121], 1.0 op_sel_hi:[1,0]
    v_pk_add_f32 v[226:227], v[128:129], 1.0 op_sel_hi:[1,0]
    v_pk_fma_f32 v[220:221], v[152:153], v[122:123], v[152:153]
    v_pk_fma_f32 v[222:223], v[160:161], v[130:131], v[160:161]
    v_pk_fma_f32 v[220:221], v[154:155], v[224:225], v[220:221]
    v_pk_fma_f32 v[222:223], v[162:163], v[226:227], v[222:223]
    v_pk_fma_f32 v[224:225], v[224:225], v[122:123], v[224:225]
    v_pk_fma_f32 v[226:227], v[226:227], v[130:131], v[226:227]
    v_pk_fma_f32 v[220:221], v[220:221], v[124:125], v[220:221]
    v_pk_fma_f32 v[222:223], v[222:223], v[132:133], v[222:223]
    v_pk_fma_f32 v[220:221], v[156:157], v[224:225], v[220:221]
    v_pk_fma_f32 v[222:223], v[164:165], v[226:227], v[222:223]
    v_pk_fma_f32 v[224:225], v[224:225], v[124:125], v[224:225]
    v_pk_fma_f32 v[226:227], v[226:227], v[132:133], v[226:227]
    v_pk_fma_f32 v[220:221], v[220:221], v[126:127], v[220:221]
    v_pk_fma_f32 v[222:223], v[222:223], v[134:135], v[222:223]
    v_pk_fma_f32 v[220:221], v[158:159], v[224:225], v[220:221]
    v_pk_fma_f32 v[222:223], v[166:167], v[226:227], v[222:223]
    v_pk_fma_f32 v[224:225], v[224:225], v[126:127], v[224:225]
    v_pk_fma_f32 v[226:227], v[226:227], v[134:135], v[226:227]
    v_pk_fma_f32 v[14:15], v[224:225], v[226:227], v[14:15]
    s_cbranch_scc1 FINF_1
    .p2align 6
LOOPF:
    s_setprio 1
    v_mfma_f32_16x16x32_bf16 v[120:123], v[206:209], v[98:101], 0
    v_cvt_f64_f32 v[228:229], v244
    v_cvt_f64_f32 v[230:231], v245
    v_mfma_f32_16x16x32_bf16 v[120:123], v[184:187], v[32:35], v[120:123]
    v_cvt_f64_f32 v[232:233], v246
    v_cvt_f64_f32 v[234:235], v247
    v_mfma_f32_16x16x32_bf16 v[120:123], v[188:191], v[36:39], v[120:123]
    v_rcp_f32 v224, v224
    v_mfma_f32_16x16x32_bf16 v[124:127], v[210:213], v[96:99], 0
    v_rcp_f32 v225, v225
    v_mfma_f32_16x16x32_bf16 v[124:127], v[192:195], v[32:35], v[124:127]
    v_rcp_f32 v226, v226
    v_mfma_f32_16x16x32_bf16 v[124:127], v[196:199], v[36:39], v[124:127]
    v_rcp_f32 v227, v227
    v_mfma_f32_16x16x32_bf16 v[128:131], v[206:209], v[104:107], 0
    v_exp_f32 v136, v136
    v_mfma_f32_16x16x32_bf16 v[128:131], v[184:187], v[40:43], v[128:131]
    v_exp_f32 v137, v137
    v_mfma_f32_16x16x32_bf16 v[128:131], v[188:191], v[44:47], v[128:131]
    v_exp_f32 v138, v138
    v_mfma_f32_16x16x32_bf16 v[132:135], v[210:213], v[102:105], 0
    v_exp_f32 v139, v139
    v_mfma_f32_16x16x32_bf16 v[132:135], v[192:195], v[40:43], v[132:135]
    v_exp_f32 v140, v140
    v_mfma_f32_16x16x32_bf16 v[132:135], v[196:199], v[44:47], v[132:135]
    v_exp_f32 v141, v141
    v_mfma_f32_16x16x32_bf16 v[152:155], v[184:187], v[64:67], 0
    v_exp_f32 v142, v142
    v_mfma_f32_16x16x32_bf16 v[152:155], v[188:191], v[68:71], v[152:155]
    v_exp_f32 v143, v143
    v_mfma_f32_16x16x32_bf16 v[156:159], v[192:195], v[64:67], 0
    v_exp_f32 v144, v144
    v_mfma_f32_16x16x32_bf16 v[156:159], v[196:199], v[68:71], v[156:159]
    v_exp_f32 v145, v145
    v_mfma_f32_16x16x32_bf16 v[160:163], v[184:187], v[72:75], 0
    v_exp_f32 v146, v146
    v_mfma_f32_16x16x32_bf16 v[160:163], v[188:191], v[76:79], v[160:163]
    v_exp_f32 v147, v147
    v_mfma_f32_16x16x32_bf16 v[164:167], v[192:195], v[72:75], 0
    v_exp_f32 v148, v148
    v_mfma_f32_16x16x32_bf16 v[164:167], v[196:199], v[76:79], v[164:167]
    v_exp_f32 v149, v149
    v_exp_f32 v150, v150
    v_exp_f32 v151, v151
    s_setprio 0
    buffer_load_dwordx4 v[202:205], v[248:249], s[28:31], 0 idxen offen
    ds_read_u16 v16, v4 offset:6278
    ds_read_u16 v17, v4 offset:6310
    ds_read_b128 v[236:239], v2 offset:8320
    ds_read_b128 v[240:243], v2 offset:8336
    ds_add_f64 v26, v[228:229] offset:256
    ds_add_f64 v27, v[230:231] offset:256
    ds_add_f64 v26, v[232:233] offset:384
    ds_add_f64 v27, v[234:235] offset:384
    ds_read_b32 v110, v24 offset:640
    ds_read_b32 v111, v25 offset:640
    ds_read_b32 v116, v24 offset:644
    ds_read_b32 v117, v25 offset:644
    s_waitcnt lgkmcnt(0)
    v_pk_mul_f32 v[244:245], v[220:221], v[224:225]
    v_pk_mul_f32 v[246:247], v[222:223], v[226:227]
    v_pk_add_f32 v[224:225], v[136:137], 1.0 op_sel_hi:[1,0]
    v_pk_add_f32 v[226:227], v[144:145], 1.0 op_sel_hi:[1,0]
    v_pk_fma_f32 v[220:221], v[168:169], v[138:139], v[168:169]
    v_pk_fma_f32 v[222:223], v[176:177], v[146:147], v[176:177]
    v_pk_fma_f32 v[220:221], v[170:171], v[224:225], v[220:221]
    v_pk_fma_f32 v[222:223], v[178:179], v[226:227], v[222:223]
    v_pk_fma_f32 v[224:225], v[224:225], v[138:139], v[224:225]
    v_pk_fma_f32 v[226:227], v[226:227], v[146:147], v[226:227]
    v_pk_fma_f32 v[220:221], v[220:221], v[140:141], v[220:221]
    v_pk_fma_f32 v[222:223], v[222:223], v[148:149], v[222:223]
    v_pk_fma_f32 v[220:221], v[172:173], v[224:225], v[220:221]
    v_pk_fma_f32 v[222:223], v[180:181], v[226:227], v[222:223]
    v_pk_fma_f32 v[224:225], v[224:225], v[140:141], v[224:225]
    v_pk_fma_f32 v[226:227], v[226:227], v[148:149], v[226:227]
    v_pk_fma_f32 v[220:221], v[220:221], v[142:143], v[220:221]
    v_pk_fma_f32 v[222:223], v[222:223], v[150:151], v[222:223]
    v_pk_fma_f32 v[220:221], v[174:175], v[224:225], v[220:221]
    v_pk_fma_f32 v[222:223], v[182:183], v[226:227], v[222:223]
    v_pk_fma_f32 v[224:225], v[224:225], v[142:143], v[224:225]
    v_pk_fma_f32 v[226:227], v[226:227], v[150:151], v[226:227]
    v_pk_fma_f32 v[14:15], v[224:225], v[226:227], v[14:15]
    s_setprio 1
    v_mfma_f32_16x16x32_bf16 v[136:139], v[206:209], v[110:113], 0
    v_cvt_f64_f32 v[228:229], v244
    v_cvt_f64_f32 v[230:231], v245
    v_mfma_f32_16x16x32_bf16 v[136:139], v[184:187], v[48:51], v[136:139]
    v_cvt_f64_f32 v[232:233], v246
    v_cvt_f64_f32 v[234:235], v247
    v_mfma_f32_16x16x32_bf16 v[136:139], v[188:191], v[52:55], v[136:139]
    v_rcp_f32 v224, v224
    v_mfma_f32_16x16x32_bf16 v[140:143], v[210:213], v[108:111], 0
    v_rcp_f32 v225, v225
    v_mfma_f32_16x16x32_bf16 v[140:143], v[192:195], v[48:51], v[140:143]
    v_rcp_f32 v226, v226
    v_mfma_f32_16x16x32_bf16 v[140:143], v[196:199], v[52:55], v[140:143]
    v_rcp_f32 v227, v227
    v_mfma_f32_16x16x32_bf16 v[144:147], v[206:209], v[116:119], 0
    v_mad_u32_u24 v26, v16, s11, v6
    v_mad_u32_u24 v27, v17, s11, v6
    v_mfma_f32_16x16x32_bf16 v[144:147], v[184:187], v[56:59], v[144:147]
    v_mad_u32_u16 v236, v237, s55, v250
    v_mad_u32_u16 v238, v239, s55, v251
    v_mfma_f32_16x16x32_bf16 v[144:147], v[188:191], v[60:63], v[144:147]
    v_mad_u32_u16 v240, v241, s55, v252
    v_mad_u32_u16 v242, v243, s55, v253
    v_mfma_f32_16x16x32_bf16 v[148:151], v[210:213], v[114:117], 0
    v_exp_f32 v120, v120
    v_mfma_f32_16x16x32_bf16 v[148:151], v[192:195], v[56:59], v[148:151]
    v_exp_f32 v121, v121
    v_mfma_f32_16x16x32_bf16 v[148:151], v[196:199], v[60:63], v[148:151]
    v_exp_f32 v122, v122
    v_mfma_f32_16x16x32_bf16 v[168:171], v[184:187], v[80:83], 0
    v_exp_f32 v123, v123
    v_mfma_f32_16x16x32_bf16 v[168:171], v[188:191], v[84:87], v[168:171]
    v_exp_f32 v124, v124
    v_mfma_f32_16x16x32_bf16 v[172:175], v[192:195], v[80:83], 0
    v_exp_f32 v125, v125
    v_mfma_f32_16x16x32_bf16 v[172:175], v[196:199], v[84:87], v[172:175]
    v_exp_f32 v126, v126
    v_mfma_f32_16x16x32_bf16 v[176:179], v[184:187], v[88:91], 0
    v_exp_f32 v127, v127
    v_mfma_f32_16x16x32_bf16 v[176:179], v[188:191], v[92:95], v[176:179]
    v_exp_f32 v128, v128
    v_mfma_f32_16x16x32_bf16 v[180:183], v[192:195], v[88:91], 0
    v_exp_f32 v129, v129
    v_mfma_f32_16x16x32_bf16 v[180:183], v[196:199], v[92:95], v[180:183]
    v_exp_f32 v130, v130
    v_exp_f32 v131, v131
    v_exp_f32 v132, v132
    v_exp_f32 v133, v133
    v_exp_f32 v134, v134
    v_exp_f32 v135, v135
    s_setprio 0
    s_waitcnt vmcnt(1)
    ds_read_b128 v[184:187], v12 offset:0
    ds_read_b128 v[188:191], v13 offset:0
    ds_read_b128 v[192:195], v12 offset:1024
    ds_read_b128 v[196:199], v13 offset:1024
    ds_read_b32 v248, v3 offset:10368
    ds_add_f64 v22, v[228:229] offset:0
    ds_add_f64 v23, v[230:231] offset:0
    ds_add_f64 v22, v[232:233] offset:128
    ds_add_f64 v23, v[234:235] offset:128
    ds_read_b32 v98, v26 offset:512
    ds_read_b32 v99, v27 offset:512
    ds_read_b32 v104, v26 offset:516
    ds_read_b32 v105, v27 offset:516
    s_waitcnt lgkmcnt(9)
    buffer_load_dwordx4 v236, s[24:27], 0 offen offset:0 lds
    buffer_load_dwordx4 v238, s[24:27], 0 offen offset:1024 lds
    buffer_load_dwordx4 v240, s[24:27], 0 offen offset:2048 lds
    buffer_load_dwordx4 v242, s[24:27], 0 offen offset:3072 lds
    s_sub_u32 s51, s51, 1
    s_cmp_eq_u32 s51, 0
    s_waitcnt lgkmcnt(0)
    v_permlane16_swap_b32 v214, v216
    v_permlane16_swap_b32 v215, v217
    v_pk_mul_f32 v[244:245], v[220:221], v[224:225]
    v_pk_mul_f32 v[246:247], v[222:223], v[226:227]
    v_pk_add_f32 v[224:225], v[120:121], 1.0 op_sel_hi:[1,0]
    v_pk_add_f32 v[226:227], v[128:129], 1.0 op_sel_hi:[1,0]
    v_pk_fma_f32 v[220:221], v[152:153], v[122:123], v[152:153]
    v_pk_fma_f32 v[222:223], v[160:161], v[130:131], v[160:161]
    v_pk_fma_f32 v[220:221], v[154:155], v[224:225], v[220:221]
    v_pk_fma_f32 v[222:223], v[162:163], v[226:227], v[222:223]
    v_pk_fma_f32 v[224:225], v[224:225], v[122:123], v[224:225]
    v_pk_fma_f32 v[226:227], v[226:227], v[130:131], v[226:227]
    v_pk_fma_f32 v[220:221], v[220:221], v[124:125], v[220:221]
    v_pk_fma_f32 v[222:223], v[222:223], v[132:133], v[222:223]
    v_pk_fma_f32 v[220:221], v[156:157], v[224:225], v[220:221]
    v_pk_fma_f32 v[222:223], v[164:165], v[226:227], v[222:223]
    v_pk_fma_f32 v[224:225], v[224:225], v[124:125], v[224:225]
    v_pk_fma_f32 v[226:227], v[226:227], v[132:133], v[226:227]
    v_pk_fma_f32 v[220:221], v[220:221], v[126:127], v[220:221]
    v_pk_fma_f32 v[222:223], v[222:223], v[134:135], v[222:223]
    v_pk_fma_f32 v[220:221], v[158:159], v[224:225], v[220:221]
    v_pk_fma_f32 v[222:223], v[166:167], v[226:227], v[222:223]
    v_pk_fma_f32 v[224:225], v[224:225], v[126:127], v[224:225]
    v_pk_fma_f32 v[226:227], v[226:227], v[134:135], v[226:227]
    v_pk_fma_f32 v[14:15], v[224:225], v[226:227], v[14:15]
    s_cbranch_scc1 FINF_2
    s_setprio 1
    v_mfma_f32_16x16x32_bf16 v[120:123], v[212:215], v[98:101], 0
    v_cvt_f64_f32 v[228:229], v244
    v_cvt_f64_f32 v[230:231], v245
    v_mfma_f32_16x16x32_bf16 v[120:123], v[184:187], v[32:35], v[120:123]
    v_cvt_f64_f32 v[232:233], v246
    v_cvt_f64_f32 v[234:235], v247
    v_mfma_f32_16x16x32_bf16 v[120:123], v[188:191], v[36:39], v[120:123]
    v_rcp_f32 v224, v224
    v_mfma_f32_16x16x32_bf16 v[124:127], v[216:219], v[96:99], 0
    v_rcp_f32 v225, v225
    v_mfma_f32_16x16x32_bf16 v[124:127], v[192:195], v[32:35], v[124:127]
    v_rcp_f32 v226, v226
    v_mfma_f32_16x16x32_bf16 v[124:127], v[196:199], v[36:39], v[124:127]
    v_rcp_f32 v227, v227
    v_mfma_f32_16x16x32_bf16 v[128:131], v[212:215], v[104:107], 0
    v_exp_f32 v136, v136
    v_mfma_f32_16x16x32_bf16 v[128:131], v[184:187], v[40:43], v[128:131]
    v_exp_f32 v137, v137
    v_mfma_f32_16x16x32_bf16 v[128:131], v[188:191], v[44:47], v[128:131]
    v_exp_f32 v138, v138
    v_mfma_f32_16x16x32_bf16 v[132:135], v[216:219], v[102:105], 0
    v_exp_f32 v139, v139
    v_mfma_f32_16x16x32_bf16 v[132:135], v[192:195], v[40:43], v[132:135]
    v_exp_f32 v140, v140
    v_mfma_f32_16x16x32_bf16 v[132:135], v[196:199], v[44:47], v[132:135]
    v_exp_f32 v141, v141
    v_mfma_f32_16x16x32_bf16 v[152:155], v[184:187], v[64:67], 0
    v_exp_f32 v142, v142
    v_mfma_f32_16x16x32_bf16 v[152:155], v[188:191], v[68:71], v[152:155]
    v_exp_f32 v143, v143
    v_mfma_f32_16x16x32_bf16 v[156:159], v[192:195], v[64:67], 0
    v_exp_f32 v144, v144
    v_mfma_f32_16x16x32_bf16 v[156:159], v[196:199], v[68:71], v[156:159]
    v_exp_f32 v145, v145
    v_mfma_f32_16x16x32_bf16 v[160:163], v[184:187], v[72:75], 0
    v_exp_f32 v146, v146
    v_mfma_f32_16x16x32_bf16 v[160:163], v[188:191], v[76:79], v[160:163]
    v_exp_f32 v147, v147
    v_mfma_f32_16x16x32_bf16 v[164:167], v[192:195], v[72:75], 0
    v_exp_f32 v148, v148
    v_mfma_f32_16x16x32_bf16 v[164:167], v[196:199], v[76:79], v[164:167]
    v_exp_f32 v149, v149
    v_exp_f32 v150, v150
    v_exp_f32 v151, v151
    s_setprio 0
    buffer_load_dwordx4 v[208:211], v[248:249], s[28:31], 0 idxen offen
    ds_read_u16 v16, v4 offset:8326
    ds_read_u16 v17, v4 offset:8358
    ds_read_b128 v[236:239], v2 offset:10368
    ds_read_b128 v[240:243], v2 offset:10384
    ds_add_f64 v22, v[228:229] offset:256
    ds_add_f64 v23, v[230:231] offset:256
    ds_add_f64 v22, v[232:233] offset:384
    ds_add_f64 v23, v[234:235] offset:384
    ds_read_b32 v110, v26 offset:640
    ds_read_b32 v111, v27 offset:640
    ds_read_b32 v116, v26 offset:644
    ds_read_b32 v117, v27 offset:644
    s_waitcnt lgkmcnt(0)
    v_pk_mul_f32 v[244:245], v[220:221], v[224:225]
    v_pk_mul_f32 v[246:247], v[222:223], v[226:227]
    v_pk_add_f32 v[224:225], v[136:137], 1.0 op_sel_hi:[1,0]
    v_pk_add_f32 v[226:227], v[144:145], 1.0 op_sel_hi:[1,0]
    v_pk_fma_f32 v[220:221], v[168:169], v[138:139], v[168:169]
    v_pk_fma_f32 v[222:223], v[176:177], v[146:147], v[176:177]
    v_pk_fma_f32 v[220:221], v[170:171], v[224:225], v[220:221]
    v_pk_fma_f32 v[222:223], v[178:179], v[226:227], v[222:223]
    v_pk_fma_f32 v[224:225], v[224:225], v[138:139], v[224:225]
    v_pk_fma_f32 v[226:227], v[226:227], v[146:147], v[226:227]
    v_pk_fma_f32 v[220:221], v[220:221], v[140:141], v[220:221]
    v_pk_fma_f32 v[222:223], v[222:223], v[148:149], v[222:223]
    v_pk_fma_f32 v[220:221], v[172:173], v[224:225], v[220:221]
    v_pk_fma_f32 v[222:223], v[180:181], v[226:227], v[222:223]
    v_pk_fma_f32 v[224:225], v[224:225], v[140:141], v[224:225]
    v_pk_fma_f32 v[226:227], v[226:227], v[148:149], v[226:227]
    v_pk_fma_f32 v[220:221], v[220:221], v[142:143], v[220:221]
    v_pk_fma_f32 v[222:223], v[222:223], v[150:151], v[222:223]
    v_pk_fma_f32 v[220:221], v[174:175], v[224:225], v[220:221]
    v_pk_fma_f32 v[222:223], v[182:183], v[226:227], v[222:223]
    v_pk_fma_f32 v[224:225], v[224:225], v[142:143], v[224:225]
    v_pk_fma_f32 v[226:227], v[226:227], v[150:151], v[226:227]
    v_pk_fma_f32 v[14:15], v[224:225], v[226:227], v[14:15]
    s_setprio 1
    v_mfma_f32_16x16x32_bf16 v[136:139], v[212:215], v[110:113], 0
    v_cvt_f64_f32 v[228:229], v244
    v_cvt_f64_f32 v[230:231], v245
    v_mfma_f32_16x16x32_bf16 v[136:139], v[184:187], v[48:51], v[136:139]
    v_cvt_f64_f32 v[232:233], v246
    v_cvt_f64_f32 v[234:235], v247
    v_mfma_f32_16x16x32_bf16 v[136:139], v[188:191], v[52:55], v[136:139]
    v_rcp_f32 v224, v224
    v_mfma_f32_16x16x32_bf16 v[140:143], v[216:219], v[108:111], 0
    v_rcp_f32 v225, v225
    v_mfma_f32_16x16x32_bf16 v[140:143], v[192:195], v[48:51], v[140:143]
    v_rcp_f32 v226, v226
    v_mfma_f32_16x16x32_bf16 v[140:143], v[196:199], v[52:55], v[140:143]
    v_rcp_f32 v227, v227
    v_mfma_f32_16x16x32_bf16 v[144:147], v[212:215], v[116:119], 0
    v_mad_u32_u24 v22, v16, s11, v6
    v_mad_u32_u24 v23, v17, s11, v6
    v_mfma_f32_16x16x32_bf16 v[144:147], v[184:187], v[56:59], v[144:147]
    v_mad_u32_u16 v236, v237, s55, v250
    v_mad_u32_u16 v238, v239, s55, v251
    v_mfma_f32_16x16x32_bf16 v[144:147], v[188:191], v[60:63], v[144:147]
    v_mad_u32_u16 v240, v241, s55, v252
    v_mad_u32_u16 v242, v243, s55, v253
    v_mfma_f32_16x16x32_bf16 v[148:151], v[216:219], v[114:117], 0
    v_exp_f32 v120, v120
    v_mfma_f32_16x16x32_bf16 v[148:151], v[192:195], v[56:59], v[148:151]
    v_exp_f32 v121, v121
    v_mfma_f32_16x16x32_bf16 v[148:151], v[196:199], v[60:63], v[148:151]
    v_exp_f32 v122, v122
    v_mfma_f32_16x16x32_bf16 v[168:171], v[184:187], v[80:83], 0
    v_exp_f32 v123, v123
    v_mfma_f32_16x16x32_bf16 v[168:171], v[188:191], v[84:87], v[168:171]
    v_exp_f32 v124, v124
    v_mfma_f32_16x16x32_bf16 v[172:175], v[192:195], v[80:83], 0
    v_exp_f32 v125, v125
    v_mfma_f32_16x16x32_bf16 v[172:175], v[196:199], v[84:87], v[172:175]
    v_exp_f32 v126, v126
    v_mfma_f32_16x16x32_bf16 v[176:179], v[184:187], v[88:91], 0
    v_exp_f32 v127, v127
    v_mfma_f32_16x16x32_bf16 v[176:179], v[188:191], v[92:95], v[176:179]
    v_exp_f32 v128, v128
    v_mfma_f32_16x16x32_bf16 v[180:183], v[192:195], v[88:91], 0
    v_exp_f32 v129, v129
    v_mfma_f32_16x16x32_bf16 v[180:183], v[196:199], v[92:95], v[180:183]
    v_exp_f32 v130, v130
    v_exp_f32 v131, v131
    v_exp_f32 v132, v132
    v_exp_f32 v133, v133
    v_exp_f32 v134, v134
    v_exp_f32 v135, v135
    s_setprio 0
    s_waitcnt vmcnt(1)
    ds_read_b128 v[184:187], v12 offset:0
    ds_read_b128 v[188:191], v13 offset:0
    ds_read_b128 v[192:195], v12 offset:1024
    ds_read_b128 v[196:199], v13 offset:1024
    ds_read_b32 v248, v3 offset:12416
    ds_add_f64 v24, v[228:229] offset:0
    ds_add_f64 v25, v[230:231] offset:0
    ds_add_f64 v24, v[232:233] offset:128
    ds_add_f64 v25, v[234:235] offset:128
    ds_read_b32 v98, v22 offset:512
    ds_read_b32 v99, v23 offset:512
    ds_read_b32 v104, v22 offset:516
    ds_read_b32 v105, v23 offset:516
    s_waitcnt lgkmcnt(9)
    buffer_load_dwordx4 v236, s[24:27], 0 offen offset:0 lds
    buffer_load_dwordx4 v238, s[24:27], 0 offen offset:1024 lds
    buffer_load_dwordx4 v240, s[24:27], 0 offen offset:2048 lds
    buffer_load_dwordx4 v242, s[24:27], 0 offen offset:3072 lds
    s_sub_u32 s51, s51, 1
    s_cmp_eq_u32 s51, 0
    s_waitcnt lgkmcnt(0)
    v_permlane16_swap_b32 v202, v204
    v_permlane16_swap_b32 v203, v205
    v_pk_mul_f32 v[244:245], v[220:221], v[224:225]
    v_pk_mul_f32 v[246:247], v[222:223], v[226:227]
    v_pk_add_f32 v[224:225], v[120:121], 1.0 op_sel_hi:[1,0]
    v_pk_add_f32 v[226:227], v[128:129], 1.0 op_sel_hi:[1,0]
    v_pk_fma_f32 v[220:221], v[152:153], v[122:123], v[152:153]
    v_pk_fma_f32 v[222:223], v[160:161], v[130:131], v[160:161]
    v_pk_fma_f32 v[220:221], v[154:155], v[224:225], v[220:221]
    v_pk_fma_f32 v[222:223], v[162:163], v[226:227], v[222:223]
    v_pk_fma_f32 v[224:225], v[224:225], v[122:123], v[224:225]
    v_pk_fma_f32 v[226:227], v[226:227], v[130:131], v[226:227]
    v_pk_fma_f32 v[220:221], v[220:221], v[124:125], v[220:221]
    v_pk_fma_f32 v[222:223], v[222:223], v[132:133], v[222:223]
    v_pk_fma_f32 v[220:221], v[156:157], v[224:225], v[220:221]
    v_pk_fma_f32 v[222:223], v[164:165], v[226:227], v[222:223]
    v_pk_fma_f32 v[224:225], v[224:225], v[124:125], v[224:225]
    v_pk_fma_f32 v[226:227], v[226:227], v[132:133], v[226:227]
    v_pk_fma_f32 v[220:221], v[220:221], v[126:127], v[220:221]
    v_pk_fma_f32 v[222:223], v[222:223], v[134:135], v[222:223]
    v_pk_fma_f32 v[220:221], v[158:159], v[224:225], v[220:221]
    v_pk_fma_f32 v[222:223], v[166:167], v[226:227], v[222:223]
    v_pk_fma_f32 v[224:225], v[224:225], v[126:127], v[224:225]
    v_pk_fma_f32 v[226:227], v[226:227], v[134:135], v[226:227]
    v_pk_fma_f32 v[14:15], v[224:225], v[226:227], v[14:15]
    s_cbranch_scc1 FINF_0
    s_setprio 1
    v_mfma_f32_16x16x32_bf16 v[120:123], v[200:203], v[98:101], 0
    v_cvt_f64_f32 v[228:229], v244
    v_cvt_f64_f32 v[230:231], v245
    v_mfma_f32_16x16x32_bf16 v[120:123], v[184:187], v[32:35], v[120:123]
    v_cvt_f64_f32 v[232:233], v246
    v_cvt_f64_f32 v[234:235], v247
    v_mfma_f32_16x16x32_bf16 v[120:123], v[188:191], v[36:39], v[120:123]
    v_rcp_f32 v224, v224
    v_mfma_f32_16x16x32_bf16 v[124:127], v[204:207], v[96:99], 0
    v_rcp_f32 v225, v225
    v_mfma_f32_16x16x32_bf16 v[124:127], v[192:195], v[32:35], v[124:127]
    v_rcp_f32 v226, v226
    v_mfma_f32_16x16x32_bf16 v[124:127], v[196:199], v[36:39], v[124:127]
    v_rcp_f32 v227, v227
    v_mfma_f32_16x16x32_bf16 v[128:131], v[200:203], v[104:107], 0
    v_add_u32 v4, 0x1800, v4
    v_add_u32 v2, 0x1800, v2
    v_add_u32 v3, 0x1800, v3
    v_mfma_f32_16x16x32_bf16 v[128:131], v[184:187], v[40:43], v[128:131]
    v_exp_f32 v136, v136
    v_mfma_f32_16x16x32_bf16 v[128:131], v[188:191], v[44:47], v[128:131]
    v_exp_f32 v137, v137
    v_mfma_f32_16x16x32_bf16 v[132:135], v[204:207], v[102:105], 0
    v_exp_f32 v138, v138
    v_mfma_f32_16x16x32_bf16 v[132:135], v[192:195], v[40:43], v[132:135]
    v_exp_f32 v139, v139
    v_mfma_f32_16x16x32_bf16 v[132:135], v[196:199], v[44:47], v[132:135]
    v_exp_f32 v140, v140
    v_mfma_f32_16x16x32_bf16 v[152:155], v[184:187], v[64:67], 0
    v_exp_f32 v141, v141
    v_mfma_f32_16x16x32_bf16 v[152:155], v[188:191], v[68:71], v[152:155]
    v_exp_f32 v142, v142
    v_mfma_f32_16x16x32_bf16 v[156:159], v[192:195], v[64:67], 0
    v_exp_f32 v143, v143
    v_mfma_f32_16x16x32_bf16 v[156:159], v[196:199], v[68:71], v[156:159]
    v_exp_f32 v144, v144
    v_mfma_f32_16x16x32_bf16 v[160:163], v[184:187], v[72:75], 0
    v_exp_f32 v145, v145
    v_mfma_f32_16x16x32_bf16 v[160:163], v[188:191], v[76:79], v[160:163]
    v_exp_f32 v146, v146
    v_mfma_f32_16x16x32_bf16 v[164:167], v[192:195], v[72:75], 0
    v_exp_f32 v147, v147
    v_mfma_f32_16x16x32_bf16 v[164:167], v[196:199], v[76:79], v[164:167]
    v_exp_f32 v148, v148
    v_exp_f32 v149, v149
    v_exp_f32 v150, v150
    v_exp_f32 v151, v151
    s_setprio 0
    buffer_load_dwordx4 v[214:217], v[248:249], s[28:31], 0 idxen offen
    ds_read_u16 v16, v4 offset:4230
    ds_read_u16 v17, v4 offset:4262
    ds_read_b128 v[236:239], v2 offset:6272
    ds_read_b128 v[240:243], v2 offset:6288
    ds_add_f64 v24, v[228:229] offset:256
    ds_add_f64 v25, v[230:231] offset:256
    ds_add_f64 v24, v[232:233] offset:384
    ds_add_f64 v25, v[234:235] offset:384
    ds_read_b32 v110, v22 offset:640
    ds_read_b32 v111, v23 offset:640
    ds_read_b32 v116, v22 offset:644
    ds_read_b32 v117, v23 offset:644
    s_waitcnt lgkmcnt(0)
    v_pk_mul_f32 v[244:245], v[220:221], v[224:225]
    v_pk_mul_f32 v[246:247], v[222:223], v[226:227]
    v_pk_add_f32 v[224:225], v[136:137], 1.0 op_sel_hi:[1,0]
    v_pk_add_f32 v[226:227], v[144:145], 1.0 op_sel_hi:[1,0]
    v_pk_fma_f32 v[220:221], v[168:169], v[138:139], v[168:169]
    v_pk_fma_f32 v[222:223], v[176:177], v[146:147], v[176:177]
    v_pk_fma_f32 v[220:221], v[170:171], v[224:225], v[220:221]
    v_pk_fma_f32 v[222:223], v[178:179], v[226:227], v[222:223]
    v_pk_fma_f32 v[224:225], v[224:225], v[138:139], v[224:225]
    v_pk_fma_f32 v[226:227], v[226:227], v[146:147], v[226:227]
    v_pk_fma_f32 v[220:221], v[220:221], v[140:141], v[220:221]
    v_pk_fma_f32 v[222:223], v[222:223], v[148:149], v[222:223]
    v_pk_fma_f32 v[220:221], v[172:173], v[224:225], v[220:221]
    v_pk_fma_f32 v[222:223], v[180:181], v[226:227], v[222:223]
    v_pk_fma_f32 v[224:225], v[224:225], v[140:141], v[224:225]
    v_pk_fma_f32 v[226:227], v[226:227], v[148:149], v[226:227]
    v_pk_fma_f32 v[220:221], v[220:221], v[142:143], v[220:221]
    v_pk_fma_f32 v[222:223], v[222:223], v[150:151], v[222:223]
    v_pk_fma_f32 v[220:221], v[174:175], v[224:225], v[220:221]
    v_pk_fma_f32 v[222:223], v[182:183], v[226:227], v[222:223]
    v_pk_fma_f32 v[224:225], v[224:225], v[142:143], v[224:225]
    v_pk_fma_f32 v[226:227], v[226:227], v[150:151], v[226:227]
    v_pk_fma_f32 v[14:15], v[224:225], v[226:227], v[14:15]
    s_setprio 1
    v_mfma_f32_16x16x32_bf16 v[136:139], v[200:203], v[110:113], 0
    v_cvt_f64_f32 v[228:229], v244
    v_cvt_f64_f32 v[230:231], v245
    v_mfma_f32_16x16x32_bf16 v[136:139], v[184:187], v[48:51], v[136:139]
    v_cvt_f64_f32 v[232:233], v246
    v_cvt_f64_f32 v[234:235], v247
    v_mfma_f32_16x16x32_bf16 v[136:139], v[188:191], v[52:55], v[136:139]
    v_rcp_f32 v224, v224
    v_mfma_f32_16x16x32_bf16 v[140:143], v[204:207], v[108:111], 0
    v_rcp_f32 v225, v225
    v_mfma_f32_16x16x32_bf16 v[140:143], v[192:195], v[48:51], v[140:143]
    v_rcp_f32 v226, v226
    v_mfma_f32_16x16x32_bf16 v[140:143], v[196:199], v[52:55], v[140:143]
    v_rcp_f32 v227, v227
    v_mfma_f32_16x16x32_bf16 v[144:147], v[200:203], v[116:119], 0
    v_mad_u32_u24 v24, v16, s11, v6
    v_mad_u32_u24 v25, v17, s11, v6
    v_mfma_f32_16x16x32_bf16 v[144:147], v[184:187], v[56:59], v[144:147]
    v_mad_u32_u16 v236, v237, s55, v250
    v_mad_u32_u16 v238, v239, s55, v251
    v_mfma_f32_16x16x32_bf16 v[144:147], v[188:191], v[60:63], v[144:147]
    v_mad_u32_u16 v240, v241, s55, v252
    v_mad_u32_u16 v242, v243, s55, v253
    v_mfma_f32_16x16x32_bf16 v[148:151], v[204:207], v[114:117], 0
    v_exp_f32 v120, v120
    v_mfma_f32_16x16x32_bf16 v[148:151], v[192:195], v[56:59], v[148:151]
    v_exp_f32 v121, v121
    v_mfma_f32_16x16x32_bf16 v[148:151], v[196:199], v[60:63], v[148:151]
    v_exp_f32 v122, v122
    v_mfma_f32_16x16x32_bf16 v[168:171], v[184:187], v[80:83], 0
    v_exp_f32 v123, v123
    v_mfma_f32_16x16x32_bf16 v[168:171], v[188:191], v[84:87], v[168:171]
    v_exp_f32 v124, v124
    v_mfma_f32_16x16x32_bf16 v[172:175], v[192:195], v[80:83], 0
    v_exp_f32 v125, v125
    v_mfma_f32_16x16x32_bf16 v[172:175], v[196:199], v[84:87], v[172:175]
    v_exp_f32 v126, v126
    v_mfma_f32_16x16x32_bf16 v[176:179], v[184:187], v[88:91], 0
    v_exp_f32 v127, v127
    v_mfma_f32_16x16x32_bf16 v[176:179], v[188:191], v[92:95], v[176:179]
    v_exp_f32 v128, v128
    v_mfma_f32_16x16x32_bf16 v[180:183], v[192:195], v[88:91], 0
    v_exp_f32 v129, v129
    v_mfma_f32_16x16x32_bf16 v[180:183], v[196:199], v[92:95], v[180:183]
    v_exp_f32 v130, v130
    v_exp_f32 v131, v131
    v_exp_f32 v132, v132
    v_exp_f32 v133, v133
    v_exp_f32 v134, v134
    v_exp_f32 v135, v135
    s_setprio 0
    s_waitcnt vmcnt(1)
    ds_read_b128 v[184:187], v12 offset:0
    ds_read_b128 v[188:191], v13 offset:0
    ds_read_b128 v[192:195], v12 offset:1024
    ds_read_b128 v[196:199], v13 offset:1024
    ds_read_b32 v248, v3 offset:8320
    ds_add_f64 v26, v[228:229] offset:0
    ds_add_f64 v27, v[230:231] offset:0
    ds_add_f64 v26, v[232:233] offset:128
    ds_add_f64 v27, v[234:235] offset:128
    ds_read_b32 v98, v24 offset:512
    ds_read_b32 v99, v25 offset:512
    ds_read_b32 v104, v24 offset:516
    ds_read_b32 v105, v25 offset:516
    s_waitcnt lgkmcnt(9)
    buffer_load_dwordx4 v236, s[24:27], 0 offen offset:0 lds
    buffer_load_dwordx4 v238, s[24:27], 0 offen offset:1024 lds
    buffer_load_dwordx4 v240, s[24:27], 0 offen offset:2048 lds
    buffer_load_dwordx4 v242, s[24:27], 0 offen offset:3072 lds
    s_sub_u32 s51, s51, 1
    s_cmp_eq_u32 s51, 0
    s_waitcnt lgkmcnt(0)
    v_permlane16_swap_b32 v208, v210
    v_permlane16_swap_b32 v209, v211
    v_pk_mul_f32 v[244:245], v[220:221], v[224:225]
    v_pk_mul_f32 v[246:247], v[222:223], v[226:227]
    v_pk_add_f32 v[224:225], v[120:121], 1.0 op_sel_hi:[1,0]
    v_pk_add_f32 v[226:227], v[128:129], 1.0 op_sel_hi:[1,0]
    v_pk_fma_f32 v[220:221], v[152:153], v[122:123], v[152:153]
    v_pk_fma_f32 v[222:223], v[160:161], v[130:131], v[160:161]
    v_pk_fma_f32 v[220:221], v[154:155], v[224:225], v[220:221]
    v_pk_fma_f32 v[222:223], v[162:163], v[226:227], v[222:223]
    v_pk_fma_f32 v[224:225], v[224:225], v[122:123], v[224:225]
    v_pk_fma_f32 v[226:227], v[226:227], v[130:131], v[226:227]
    v_pk_fma_f32 v[220:221], v[220:221], v[124:125], v[220:221]
    v_pk_fma_f32 v[222:223], v[222:223], v[132:133], v[222:223]
    v_pk_fma_f32 v[220:221], v[156:157], v[224:225], v[220:221]
    v_pk_fma_f32 v[222:223], v[164:165], v[226:227], v[222:223]
    v_pk_fma_f32 v[224:225], v[224:225], v[124:125], v[224:225]
    v_pk_fma_f32 v[226:227], v[226:227], v[132:133], v[226:227]
    v_pk_fma_f32 v[220:221], v[220:221], v[126:127], v[220:221]
    v_pk_fma_f32 v[222:223], v[222:223], v[134:135], v[222:223]
    v_pk_fma_f32 v[220:221], v[158:159], v[224:225], v[220:221]
    v_pk_fma_f32 v[222:223], v[166:167], v[226:227], v[222:223]
    v_pk_fma_f32 v[224:225], v[224:225], v[126:127], v[224:225]
    v_pk_fma_f32 v[226:227], v[226:227], v[134:135], v[226:227]
    v_pk_fma_f32 v[14:15], v[224:225], v[226:227], v[14:15]
    s_cbranch_scc0 LOOPF
FINF_1:
    v_cvt_f64_f32 v[228:229], v244
    v_cvt_f64_f32 v[230:231], v245
    v_cvt_f64_f32 v[232:233], v246
    v_cvt_f64_f32 v[234:235], v247
    v_rcp_f32 v224, v224
    v_rcp_f32 v225, v225
    v_rcp_f32 v226, v226
    v_rcp_f32 v227, v227
    v_exp_f32 v136, v136
    v_exp_f32 v137, v137
    v_exp_f32 v138, v138
    v_exp_f32 v139, v139
    v_exp_f32 v140, v140
    v_exp_f32 v141, v141
    v_exp_f32 v142, v142
    v_exp_f32 v143, v143
    v_exp_f32 v144, v144
    v_exp_f32 v145, v145
    v_exp_f32 v146, v146
    v_exp_f32 v147, v147
    v_exp_f32 v148, v148
    v_exp_f32 v149, v149
    v_exp_f32 v150, v150
    v_exp_f32 v151, v151
    ds_add_f64 v26, v[228:229] offset:256
    ds_add_f64 v27, v[230:231] offset:256
    ds_add_f64 v26, v[232:233] offset:384
    ds_add_f64 v27, v[234:235] offset:384
    s_nop 0
    v_pk_mul_f32 v[244:245], v[220:221], v[224:225]
    v_pk_mul_f32 v[246:247], v[222:223], v[226:227]
    v_pk_add_f32 v[224:225], v[136:137], 1.0 op_sel_hi:[1,0]
    v_pk_add_f32 v[226:227], v[144:145], 1.0 op_sel_hi:[1,0]
    v_pk_fma_f32 v[220:221], v[168:169], v[138:139], v[168:169]
    v_pk_fma_f32 v[222:223], v[176:177], v[146:147], v[176:177]
    v_pk_fma_f32 v[220:221], v[170:171], v[224:225], v[220:221]
    v_pk_fma_f32 v[222:223], v[178:179], v[226:227], v[222:223]
    v_pk_fma_f32 v[224:225], v[224:225], v[138:139], v[224:225]
    v_pk_fma_f32 v[226:227], v[226:227], v[146:147], v[226:227]
    v_pk_fma_f32 v[220:221], v[220:221], v[140:141], v[220:221]
    v_pk_fma_f32 v[222:223], v[222:223], v[148:149], v[222:223]
    v_pk_fma_f32 v[220:221], v[172:173], v[224:225], v[220:221]
    v_pk_fma_f32 v[222:223], v[180:181], v[226:227], v[222:223]
    v_pk_fma_f32 v[224:225], v[224:225], v[140:141], v[224:225]
    v_pk_fma_f32 v[226:227], v[226:227], v[148:149], v[226:227]
    v_pk_fma_f32 v[220:221], v[220:221], v[142:143], v[220:221]
    v_pk_fma_f32 v[222:223], v[222:223], v[150:151], v[222:223]
    v_pk_fma_f32 v[220:221], v[174:175], v[224:225], v[220:221]
    v_pk_fma_f32 v[222:223], v[182:183], v[226:227], v[222:223]
    v_pk_fma_f32 v[224:225], v[224:225], v[142:143], v[224:225]
    v_pk_fma_f32 v[226:227], v[226:227], v[150:151], v[226:227]
    v_pk_fma_f32 v[14:15], v[224:225], v[226:227], v[14:15]
    v_cvt_f64_f32 v[228:229], v244
    v_cvt_f64_f32 v[230:231], v245
    v_cvt_f64_f32 v[232:233], v246
    v_cvt_f64_f32 v[234:235], v247
    v_rcp_f32 v224, v224
    v_rcp_f32 v225, v225
    v_rcp_f32 v226, v226
    v_rcp_f32 v227, v227
    ds_add_f64 v22, v[228:229] offset:0
    ds_add_f64 v23, v[230:231] offset:0
    ds_add_f64 v22, v[232:233] offset:128
    ds_add_f64 v23, v[234:235] offset:128
    s_nop 0
    v_pk_mul_f32 v[244:245], v[220:221], v[224:225]
    v_pk_mul_f32 v[246:247], v[222:223], v[226:227]
    v_cvt_f64_f32 v[228:229], v244
    v_cvt_f64_f32 v[230:231], v245
    v_cvt_f64_f32 v[232:233], v246
    v_cvt_f64_f32 v[234:235], v247
    ds_add_f64 v22, v[228:229] offset:256
    ds_add_f64 v23, v[230:231] offset:256
    ds_add_f64 v22, v[232:233] offset:384
    ds_add_f64 v23, v[234:235] offset:384
    s_nop 0
    s_branch MAIN_DONE
FINF_2:
    v_cvt_f64_f32 v[228:229], v244
    v_cvt_f64_f32 v[230:231], v245
    v_cvt_f64_f32 v[232:233], v246
    v_cvt_f64_f32 v[234:235], v247
    v_rcp_f32 v224, v224
    v_rcp_f32 v225, v225
    v_rcp_f32 v226, v226
    v_rcp_f32 v227, v227
    v_exp_f32 v136, v136
    v_exp_f32 v137, v137
    v_exp_f32 v138, v138
    v_exp_f32 v139, v139
    v_exp_f32 v140, v140
    v_exp_f32 v141, v141
    v_exp_f32 v142, v142
    v_exp_f32 v143, v143
    v_exp_f32 v144, v144
    v_exp_f32 v145, v145
    v_exp_f32 v146, v146
    v_exp_f32 v147, v147
    v_exp_f32 v148, v148
    v_exp_f32 v149, v149
    v_exp_f32 v150, v150
    v_exp_f32 v151, v151
    ds_add_f64 v22, v[228:229] offset:256
    ds_add_f64 v23, v[230:231] offset:256
    ds_add_f64 v22, v[232:233] offset:384
    ds_add_f64 v23, v[234:235] offset:384
    s_nop 0
    v_pk_mul_f32 v[244:245], v[220:221], v[224:225]
    v_pk_mul_f32 v[246:247], v[222:223], v[226:227]
    v_pk_add_f32 v[224:225], v[136:137], 1.0 op_sel_hi:[1,0]
    v_pk_add_f32 v[226:227], v[144:145], 1.0 op_sel_hi:[1,0]
    v_pk_fma_f32 v[220:221], v[168:169], v[138:139], v[168:169]
    v_pk_fma_f32 v[222:223], v[176:177], v[146:147], v[176:177]
    v_pk_fma_f32 v[220:221], v[170:171], v[224:225], v[220:221]
    v_pk_fma_f32 v[222:223], v[178:179], v[226:227], v[222:223]
    v_pk_fma_f32 v[224:225], v[224:225], v[138:139], v[224:225]
    v_pk_fma_f32 v[226:227], v[226:227], v[146:147], v[226:227]
    v_pk_fma_f32 v[220:221], v[220:221], v[140:141], v[220:221]
    v_pk_fma_f32 v[222:223], v[222:223], v[148:149], v[222:223]
    v_pk_fma_f32 v[220:221], v[172:173], v[224:225], v[220:221]
    v_pk_fma_f32 v[222:223], v[180:181], v[226:227], v[222:223]
    v_pk_fma_f32 v[224:225], v[224:225], v[140:141], v[224:225]
    v_pk_fma_f32 v[226:227], v[226:227], v[148:149], v[226:227]
    v_pk_fma_f32 v[220:221], v[220:221], v[142:143], v[220:221]
    v_pk_fma_f32 v[222:223], v[222:223], v[150:151], v[222:223]
    v_pk_fma_f32 v[220:221], v[174:175], v[224:225], v[220:221]
    v_pk_fma_f32 v[222:223], v[182:183], v[226:227], v[222:223]
    v_pk_fma_f32 v[224:225], v[224:225], v[142:143], v[224:225]
    v_pk_fma_f32 v[226:227], v[226:227], v[150:151], v[226:227]
    v_pk_fma_f32 v[14:15], v[224:225], v[226:227], v[14:15]
    v_cvt_f64_f32 v[228:229], v244
    v_cvt_f64_f32 v[230:231], v245
    v_cvt_f64_f32 v[232:233], v246
    v_cvt_f64_f32 v[234:235], v247
    v_rcp_f32 v224, v224
    v_rcp_f32 v225, v225
    v_rcp_f32 v226, v226
    v_rcp_f32 v227, v227
    ds_add_f64 v24, v[228:229] offset:0
    ds_add_f64 v25, v[230:231] offset:0
    ds_add_f64 v24, v[232:233] offset:128
    ds_add_f64 v25, v[234:235] offset:128
    s_nop 0
    v_pk_mul_f32 v[244:245], v[220:221], v[224:225]
    v_pk_mul_f32 v[246:247], v[222:223], v[226:227]
    v_cvt_f64_f32 v[228:229], v244
    v_cvt_f64_f32 v[230:231], v245
    v_cvt_f64_f32 v[232:233], v246
    v_cvt_f64_f32 v[234:235], v247
    ds_add_f64 v24, v[228:229] offset:256
    ds_add_f64 v25, v[230:231] offset:256
    ds_add_f64 v24, v[232:233] offset:384
    ds_add_f64 v25, v[234:235] offset:384
    s_nop 0
    s_branch MAIN_DONE
FINF_0:
    v_cvt_f64_f32 v[228:229], v244
    v_cvt_f64_f32 v[230:231], v245
    v_cvt_f64_f32 v[232:233], v246
    v_cvt_f64_f32 v[234:235], v247
    v_rcp_f32 v224, v224
    v_rcp_f32 v225, v225
    v_rcp_f32 v226, v226
    v_rcp_f32 v227, v227
    v_exp_f32 v136, v136
    v_exp_f32 v137, v137
    v_exp_f32 v138, v138
    v_exp_f32 v139, v139
    v_exp_f32 v140, v140
    v_exp_f32 v141, v141
    v_exp_f32 v142, v142
    v_exp_f32 v143, v143
    v_exp_f32 v144, v144
    v_exp_f32 v145, v145
    v_exp_f32 v146, v146
    v_exp_f32 v147, v147
    v_exp_f32 v148, v148
    v_exp_f32 v149, v149
    v_exp_f32 v150, v150
    v_exp_f32 v151, v151
    ds_add_f64 v24, v[228:229] offset:256
    ds_add_f64 v25, v[230:231] offset:256
    ds_add_f64 v24, v[232:233] offset:384
    ds_add_f64 v25, v[234:235] offset:384
    s_nop 0
    v_pk_mul_f32 v[244:245], v[220:221], v[224:225]
    v_pk_mul_f32 v[246:247], v[222:223], v[226:227]
    v_pk_add_f32 v[224:225], v[136:137], 1.0 op_sel_hi:[1,0]
    v_pk_add_f32 v[226:227], v[144:145], 1.0 op_sel_hi:[1,0]
    v_pk_fma_f32 v[220:221], v[168:169], v[138:139], v[168:169]
    v_pk_fma_f32 v[222:223], v[176:177], v[146:147], v[176:177]
    v_pk_fma_f32 v[220:221], v[170:171], v[224:225], v[220:221]
    v_pk_fma_f32 v[222:223], v[178:179], v[226:227], v[222:223]
    v_pk_fma_f32 v[224:225], v[224:225], v[138:139], v[224:225]
    v_pk_fma_f32 v[226:227], v[226:227], v[146:147], v[226:227]
    v_pk_fma_f32 v[220:221], v[220:221], v[140:141], v[220:221]
    v_pk_fma_f32 v[222:223], v[222:223], v[148:149], v[222:223]
    v_pk_fma_f32 v[220:221], v[172:173], v[224:225], v[220:221]
    v_pk_fma_f32 v[222:223], v[180:181], v[226:227], v[222:223]
    v_pk_fma_f32 v[224:225], v[224:225], v[140:141], v[224:225]
    v_pk_fma_f32 v[226:227], v[226:227], v[148:149], v[226:227]
    v_pk_fma_f32 v[220:221], v[220:221], v[142:143], v[220:221]
    v_pk_fma_f32 v[222:223], v[222:223], v[150:151], v[222:223]
    v_pk_fma_f32 v[220:221], v[174:175], v[224:225], v[220:221]
    v_pk_fma_f32 v[222:223], v[182:183], v[226:227], v[222:223]
    v_pk_fma_f32 v[224:225], v[224:225], v[142:143], v[224:225]
    v_pk_fma_f32 v[226:227], v[226:227], v[150:151], v[226:227]
    v_pk_fma_f32 v[14:15], v[224:225], v[226:227], v[14:15]
    v_cvt_f64_f32 v[228:229], v244
    v_cvt_f64_f32 v[230:231], v245
    v_cvt_f64_f32 v[232:233], v246
    v_cvt_f64_f32 v[234:235], v247
    v_rcp_f32 v224, v224
    v_rcp_f32 v225, v225
    v_rcp_f32 v226, v226
    v_rcp_f32 v227, v227
    ds_add_f64 v26, v[228:229] offset:0
    ds_add_f64 v27, v[230:231] offset:0
    ds_add_f64 v26, v[232:233] offset:128
    ds_add_f64 v27, v[234:235] offset:128
    s_nop 0
    v_pk_mul_f32 v[244:245], v[220:221], v[224:225]
    v_pk_mul_f32 v[246:247], v[222:223], v[226:227]
    v_cvt_f64_f32 v[228:229], v244
    v_cvt_f64_f32 v[230:231], v245
    v_cvt_f64_f32 v[232:233], v246
    v_cvt_f64_f32 v[234:235], v247
    ds_add_f64 v26, v[228:229] offset:256
    ds_add_f64 v27, v[230:231] offset:256
    ds_add_f64 v26, v[232:233] offset:384
    ds_add_f64 v27, v[234:235] offset:384
    s_nop 0
    s_branch MAIN_DONE
MAIN_DONE:
    s_waitcnt vmcnt(0) lgkmcnt(0)
    v_lshrrev_b32 v16, 3, v0
    v_and_b32 v17, 7, v0
    s_movk_i32 s60, 768
    v_mul_u32_u24 v18, s60, v16
    v_lshl_add_u32 v18, v17, 6, v18
    v_add_u32 v18, 67712, v18
    v_lshl_add_u32 v19, v16, 8, s58
    v_lshlrev_b32 v19, 7, v19
    v_lshl_add_u32 v19, v17, 4, v19
    v_mov_b32 v20, 0xbfb8aa3b
    v_mov_b32 v21, 0
    s_add_u32 s53, s53, s54
    s_mov_b32 s10, 0
    s_cmp_lt_u32 s53, s56
    s_barrier
    s_cbranch_scc1 PASS
    ds_read_b128 v[120:123], v18 offset:0
    ds_read_b128 v[124:127], v18 offset:16
    ds_read_b128 v[128:131], v18 offset:32
    ds_read_b128 v[132:135], v18 offset:48
    ds_read_b128 v[136:139], v18 offset:49152
    ds_read_b128 v[140:143], v18 offset:49168
    ds_read_b128 v[144:147], v18 offset:49184
    ds_read_b128 v[148:151], v18 offset:49200
    v_cmp_gt_u32 vcc, 272, v0
    s_waitcnt lgkmcnt(4)
    v_cvt_f32_f64 v152, v[120:121]
    v_cvt_f32_f64 v153, v[122:123]
    v_cvt_f32_f64 v154, v[124:125]
    v_cvt_f32_f64 v155, v[126:127]
    v_cvt_f32_f64 v156, v[128:129]
    v_cvt_f32_f64 v157, v[130:131]
    v_cvt_f32_f64 v158, v[132:133]
    v_cvt_f32_f64 v159, v[134:135]
    v_pk_mul_f32 v[160:161], v[152:153], v[20:21] op_sel_hi:[1,0]
    v_pk_mul_f32 v[162:163], v[154:155], v[20:21] op_sel_hi:[1,0]
    v_pk_mul_f32 v[164:165], v[156:157], v[20:21] op_sel_hi:[1,0]
    v_pk_mul_f32 v[166:167], v[158:159], v[20:21] op_sel_hi:[1,0]
    v_exp_f32 v160, v160
    v_exp_f32 v161, v161
    v_exp_f32 v162, v162
    v_exp_f32 v163, v163
    v_exp_f32 v164, v164
    v_exp_f32 v165, v165
    v_exp_f32 v166, v166
    v_exp_f32 v167, v167
    v_pk_fma_f32 v[14:15], v[152:153], v[20:21], v[14:15] op_sel:[0,1,0] op_sel_hi:[1,1,1]
    v_pk_fma_f32 v[14:15], v[154:155], v[20:21], v[14:15] op_sel:[0,1,0] op_sel_hi:[1,1,1]
    v_pk_fma_f32 v[14:15], v[156:157], v[20:21], v[14:15] op_sel:[0,1,0] op_sel_hi:[1,1,1]
    v_pk_fma_f32 v[14:15], v[158:159], v[20:21], v[14:15] op_sel:[0,1,0] op_sel_hi:[1,1,1]
    v_pk_add_f32 v[160:161], v[160:161], 1.0 op_sel_hi:[1,0]
    v_pk_add_f32 v[162:163], v[162:163], 1.0 op_sel_hi:[1,0]
    v_pk_add_f32 v[164:165], v[164:165], 1.0 op_sel_hi:[1,0]
    v_pk_add_f32 v[166:167], v[166:167], 1.0 op_sel_hi:[1,0]
    v_rcp_f32 v160, v160
    v_rcp_f32 v161, v161
    v_rcp_f32 v162, v162
    v_rcp_f32 v163, v163
    v_rcp_f32 v164, v164
    v_rcp_f32 v165, v165
    v_rcp_f32 v166, v166
    v_rcp_f32 v167, v167
    s_nop 0
    v_pk_mul_f32 v[152:153], v[152:153], v[160:161]
    v_pk_mul_f32 v[154:155], v[154:155], v[162:163]
    v_pk_mul_f32 v[156:157], v[156:157], v[164:165]
    v_pk_mul_f32 v[158:159], v[158:159], v[166:167]
    v_cvt_pk_bf16_f32 v168, v152, v153
    v_cvt_pk_bf16_f32 v169, v154, v155
    v_cvt_pk_bf16_f32 v170, v156, v157
    v_cvt_pk_bf16_f32 v171, v158, v159
    buffer_store_dwordx4 v[168:171], v19, s[44:47], 0 offen nt
    s_and_saveexec_b64 s[64:65], vcc
    s_cbranch_execz EPI_END
    v_add_u32 v19, 2097152, v19
    s_waitcnt lgkmcnt(0)
    v_cvt_f32_f64 v152, v[136:137]
    v_cvt_f32_f64 v153, v[138:139]
    v_cvt_f32_f64 v154, v[140:141]
    v_cvt_f32_f64 v155, v[142:143]
    v_cvt_f32_f64 v156, v[144:145]
    v_cvt_f32_f64 v157, v[146:147]
    v_cvt_f32_f64 v158, v[148:149]
    v_cvt_f32_f64 v159, v[150:151]
    v_pk_mul_f32 v[160:161], v[152:153], v[20:21] op_sel_hi:[1,0]
    v_pk_mul_f32 v[162:163], v[154:155], v[20:21] op_sel_hi:[1,0]
    v_pk_mul_f32 v[164:165], v[156:157], v[20:21] op_sel_hi:[1,0]
    v_pk_mul_f32 v[166:167], v[158:159], v[20:21] op_sel_hi:[1,0]
    v_exp_f32 v160, v160
    v_exp_f32 v161, v161
    v_exp_f32 v162, v162
    v_exp_f32 v163, v163
    v_exp_f32 v164, v164
    v_exp_f32 v165, v165
    v_exp_f32 v166, v166
    v_exp_f32 v167, v167
    v_pk_fma_f32 v[14:15], v[152:153], v[20:21], v[14:15] op_sel:[0,1,0] op_sel_hi:[1,1,1]
    v_pk_fma_f32 v[14:15], v[154:155], v[20:21], v[14:15] op_sel:[0,1,0] op_sel_hi:[1,1,1]
    v_pk_fma_f32 v[14:15], v[156:157], v[20:21], v[14:15] op_sel:[0,1,0] op_sel_hi:[1,1,1]
    v_pk_fma_f32 v[14:15], v[158:159], v[20:21], v[14:15] op_sel:[0,1,0] op_sel_hi:[1,1,1]
    v_pk_add_f32 v[160:161], v[160:161], 1.0 op_sel_hi:[1,0]
    v_pk_add_f32 v[162:163], v[162:163], 1.0 op_sel_hi:[1,0]
    v_pk_add_f32 v[164:165], v[164:165], 1.0 op_sel_hi:[1,0]
    v_pk_add_f32 v[166:167], v[166:167], 1.0 op_sel_hi:[1,0]
    v_rcp_f32 v160, v160
    v_rcp_f32 v161, v161
    v_rcp_f32 v162, v162
    v_rcp_f32 v163, v163
    v_rcp_f32 v164, v164
    v_rcp_f32 v165, v165
    v_rcp_f32 v166, v166
    v_rcp_f32 v167, v167
    s_nop 0
    v_pk_mul_f32 v[152:153], v[152:153], v[160:161]
    v_pk_mul_f32 v[154:155], v[154:155], v[162:163]
    v_pk_mul_f32 v[156:157], v[156:157], v[164:165]
    v_pk_mul_f32 v[158:159], v[158:159], v[166:167]
    v_cvt_pk_bf16_f32 v172, v152, v153
    v_cvt_pk_bf16_f32 v173, v154, v155
    v_cvt_pk_bf16_f32 v174, v156, v157
    v_cvt_pk_bf16_f32 v175, v158, v159
    buffer_store_dwordx4 v[172:175], v19, s[44:47], 0 offen nt
EPI_END:
    s_mov_b64 exec, -1
    s_cmp_lg_u32 s52, 0
    s_cbranch_scc1 K_FIN
    v_add_f32 v14, v14, v15
    v_mov_b32 v16, 24
    v_cmp_ngt_f32 vcc, 0x5d800000, v14
    v_mov_b32 v17, 1
    s_cbranch_vccz NOFLAG
    ds_write_b32 v16, v17
NOFLAG:
    s_waitcnt lgkmcnt(0)
    s_barrier
    ds_read_b32 v17, v16
    s_waitcnt lgkmcnt(0)
    v_readfirstlane_b32 s60, v17
    s_cmp_eq_u32 s60, 0
    s_cbranch_scc1 K_FIN
    s_mov_b32 s52, 1
    s_mov_b32 s53, 0
    s_movk_i32 s54, 4096
    s_waitcnt vmcnt(0)
    s_barrier
    s_branch RESTART
RETRY:
    s_add_u32 s20, s20, 1
    s_cmp_gt_u32 s20, 524288
    s_cbranch_scc1 RGOOD
    s_branch TPW
TAGAIN:
    s_cmp_eq_u32 s9, 0
    s_cbranch_scc1 TOK
    s_sub_u32 s9, s9, 1
    s_mov_b64 exec, -1
    s_branch TPOLL
XMAX:
    s_mov_b32 exec_hi, 0
    v_mov_b32 v31, 16
    v_min_u32 v17, 3200, v17
    v_mov_b32 v20, s62
    ds_max_u32 v31, v17
    ds_max_u32 v31, v20 offset:4
    s_mov_b64 exec, -1
    s_branch XBACK
NOFIT:
    s_cmp_gt_u32 s54, 16
    s_cselect_b32 s54, 16, 8
    s_mov_b32 s10, 0
    s_waitcnt vmcnt(0) lgkmcnt(0)
    s_barrier
    s_branch PASS
K_FIN:
K_END:
    s_endpgm
RAW1:
    s_lshl_b32 s60, s58, 7
    v_lshrrev_b32 v17, 3, v1
    v_lshl_add_u32 v17, v17, 17, s60
    v_add_u32 v236, v17, v250
    v_add_u32 v17, 0x8000, v17
    v_add_u32 v238, v17, v251
    v_add_u32 v17, 0x8000, v17
    v_add_u32 v240, v17, v252
    v_add_u32 v17, 0x8000, v17
    v_add_u32 v242, v17, v253
    s_mov_b32 s40, s16
    s_and_b32 s41, s17, 0xffff
    s_mov_b32 s42, 18432
    s_mov_b32 s43, 0x20000
    s_mov_b32 m0, 100480
    s_mov_b32 s60, 0
    buffer_load_dwordx4 v9, s[40:43], s60 offen offset:0 lds
    buffer_load_dwordx4 v9, s[40:43], s60 offen offset:1024 lds
    buffer_load_dwordx4 v9, s[40:43], s60 offen offset:2048 lds
    buffer_load_dwordx4 v9, s[40:43], s60 offen offset:3072 lds
    s_mov_b32 m0, 104576
    s_mov_b32 s60, 4096
    buffer_load_dwordx4 v9, s[40:43], s60 offen offset:0 lds
    buffer_load_dwordx4 v9, s[40:43], s60 offen offset:1024 lds
    buffer_load_dwordx4 v9, s[40:43], s60 offen offset:2048 lds
    buffer_load_dwordx4 v9, s[40:43], s60 offen offset:3072 lds
    s_mov_b32 m0, 108672
    s_mov_b32 s60, 8192
    buffer_load_dwordx4 v9, s[40:43], s60 offen offset:0 lds
    buffer_load_dwordx4 v9, s[40:43], s60 offen offset:1024 lds
    buffer_load_dwordx4 v9, s[40:43], s60 offen offset:2048 lds
    buffer_load_dwordx4 v9, s[40:43], s60 offen offset:3072 lds
    s_mov_b32 m0, 112768
    s_mov_b32 s60, 12288
    buffer_load_dwordx4 v9, s[40:43], s60 offen offset:0 lds
    buffer_load_dwordx4 v9, s[40:43], s60 offen offset:1024 lds
    buffer_load_dwordx4 v9, s[40:43], s60 offen offset:2048 lds
    buffer_load_dwordx4 v9, s[40:43], s60 offen offset:3072 lds
    s_mov_b32 m0, 116864
    s_mov_b32 s60, 16384
    buffer_load_dwordx4 v9, s[40:43], s60 offen offset:0 lds
    buffer_load_dwordx4 v9, s[40:43], s60 offen offset:1024 lds
    s_branch NORAW
RAW2:
    s_lshl_b32 s60, s58, 7
    v_lshrrev_b32 v17, 3, v1
    v_lshl_add_u32 v17, v17, 17, s60
    v_add_u32 v236, v17, v250
    v_add_u32 v17, 0x8000, v17
    v_add_u32 v238, v17, v251
    v_add_u32 v17, 0x8000, v17
    v_add_u32 v240, v17, v252
    v_add_u32 v17, 0x8000, v17
    v_add_u32 v242, v17, v253
    s_mov_b32 s40, s14
    s_and_b32 s41, s15, 0xffff
    s_mov_b32 s42, 8192
    s_mov_b32 s43, 0x20000
    s_mov_b32 m0, 125056
    s_mov_b32 s60, 0
    buffer_load_dwordx4 v9, s[40:43], s60 offen offset:0 lds
    buffer_load_dwordx4 v9, s[40:43], s60 offen offset:1024 lds
    buffer_load_dwordx4 v9, s[40:43], s60 offen offset:2048 lds
    buffer_load_dwordx4 v9, s[40:43], s60 offen offset:3072 lds
    s_mov_b32 m0, 129152
    s_mov_b32 s60, 4096
    buffer_load_dwordx4 v9, s[40:43], s60 offen offset:0 lds
    buffer_load_dwordx4 v9, s[40:43], s60 offen offset:1024 lds
    buffer_load_dwordx4 v9, s[40:43], s60 offen offset:2048 lds
    buffer_load_dwordx4 v9, s[40:43], s60 offen offset:3072 lds
    s_mov_b32 s40, s12
    s_and_b32 s41, s13, 0xffff
    s_mov_b32 s42, 8192
    s_mov_b32 s43, 0x20000
    s_mov_b32 m0, 133248
    s_mov_b32 s60, 0
    buffer_load_dwordx4 v9, s[40:43], s60 offen offset:0 lds
    buffer_load_dwordx4 v9, s[40:43], s60 offen offset:1024 lds
    buffer_load_dwordx4 v9, s[40:43], s60 offen offset:2048 lds
    buffer_load_dwordx4 v9, s[40:43], s60 offen offset:3072 lds
    s_mov_b32 m0, 137344
    s_mov_b32 s60, 4096
    buffer_load_dwordx4 v9, s[40:43], s60 offen offset:0 lds
    buffer_load_dwordx4 v9, s[40:43], s60 offen offset:1024 lds
    buffer_load_dwordx4 v9, s[40:43], s60 offen offset:2048 lds
    buffer_load_dwordx4 v9, s[40:43], s60 offen offset:3072 lds
    buffer_load_dword v16, off, s[72:75], 0 sc1
    s_mov_b32 m0, 67712
    s_mov_b32 s60, 0
    buffer_load_dwordx4 v236, s[24:27], s60 offen offset:0 lds
    buffer_load_dwordx4 v238, s[24:27], s60 offen offset:1024 lds
    buffer_load_dwordx4 v240, s[24:27], s60 offen offset:2048 lds
    buffer_load_dwordx4 v242, s[24:27], s60 offen offset:3072 lds
    s_mov_b32 m0, 71808
    s_mov_b32 s60, 1048576
    buffer_load_dwordx4 v236, s[24:27], s60 offen offset:0 lds
    buffer_load_dwordx4 v238, s[24:27], s60 offen offset:1024 lds
    buffer_load_dwordx4 v240, s[24:27], s60 offen offset:2048 lds
    buffer_load_dwordx4 v242, s[24:27], s60 offen offset:3072 lds
    s_mov_b32 m0, 75904
    s_mov_b32 s60, 2097152
    buffer_load_dwordx4 v236, s[24:27], s60 offen offset:0 lds
    buffer_load_dwordx4 v238, s[24:27], s60 offen offset:1024 lds
    buffer_load_dwordx4 v240, s[24:27], s60 offen offset:2048 lds
    buffer_load_dwordx4 v242, s[24:27], s60 offen offset:3072 lds
    s_mov_b32 m0, 80000
    s_mov_b32 s60, 3145728
    buffer_load_dwordx4 v236, s[24:27], s60 offen offset:0 lds
    buffer_load_dwordx4 v238, s[24:27], s60 offen offset:1024 lds
    buffer_load_dwordx4 v240, s[24:27], s60 offen offset:2048 lds
    buffer_load_dwordx4 v242, s[24:27], s60 offen offset:3072 lds
    v_mov_b32 v32, 0
    v_mov_b32 v34, 0
    v_mov_b32 v36, 0
    v_mov_b32 v38, 0
    s_mov_b32 m0, s3
    s_mov_b32 s60, 524288
    s_waitcnt vmcnt(16)
NW:
    v_readfirstlane_b32 s61, v16
    s_sub_u32 s60, s60, 1
    s_cbranch_scc1 NE
    s_cmp_lg_u32 s61, 0
    s_cbranch_scc1 NE
    buffer_load_dword v16, off, s[72:75], 0 sc1
    s_waitcnt vmcnt(0)
    s_branch NW
NE:
    v_mov_b32 v17, 0
    ds_write_b32 v17, v16
    s_branch NOPOLL1
RESTART:
    s_cmp_lg_u32 s48, 7
    s_cbranch_scc1 NORAW2
    s_lshl_b32 s60, s58, 7
    v_lshrrev_b32 v17, 3, v1
    v_lshl_add_u32 v17, v17, 17, s60
    v_add_u32 v236, v17, v250
    v_add_u32 v17, 0x8000, v17
    v_add_u32 v238, v17, v251
    v_add_u32 v17, 0x8000, v17
    v_add_u32 v240, v17, v252
    v_add_u32 v17, 0x8000, v17
    v_add_u32 v242, v17, v253
    s_mov_b32 s40, s16
    s_and_b32 s41, s17, 0xffff
    s_mov_b32 s42, 18432
    s_mov_b32 s43, 0x20000
    s_mov_b32 m0, 100480
    s_mov_b32 s60, 0
    buffer_load_dwordx4 v9, s[40:43], s60 offen offset:0 lds
    buffer_load_dwordx4 v9, s[40:43], s60 offen offset:1024 lds
    buffer_load_dwordx4 v9, s[40:43], s60 offen offset:2048 lds
    buffer_load_dwordx4 v9, s[40:43], s60 offen offset:3072 lds
    s_mov_b32 m0, 104576
    s_mov_b32 s60, 4096
    buffer_load_dwordx4 v9, s[40:43], s60 offen offset:0 lds
    buffer_load_dwordx4 v9, s[40:43], s60 offen offset:1024 lds
    buffer_load_dwordx4 v9, s[40:43], s60 offen offset:2048 lds
    buffer_load_dwordx4 v9, s[40:43], s60 offen offset:3072 lds
    s_mov_b32 m0, 108672
    s_mov_b32 s60, 8192
    buffer_load_dwordx4 v9, s[40:43], s60 offen offset:0 lds
    buffer_load_dwordx4 v9, s[40:43], s60 offen offset:1024 lds
    buffer_load_dwordx4 v9, s[40:43], s60 offen offset:2048 lds
    buffer_load_dwordx4 v9, s[40:43], s60 offen offset:3072 lds
    s_mov_b32 m0, 112768
    s_mov_b32 s60, 12288
    buffer_load_dwordx4 v9, s[40:43], s60 offen offset:0 lds
    buffer_load_dwordx4 v9, s[40:43], s60 offen offset:1024 lds
    buffer_load_dwordx4 v9, s[40:43], s60 offen offset:2048 lds
    buffer_load_dwordx4 v9, s[40:43], s60 offen offset:3072 lds
    s_mov_b32 m0, 116864
    s_mov_b32 s60, 16384
    buffer_load_dwordx4 v9, s[40:43], s60 offen offset:0 lds
    buffer_load_dwordx4 v9, s[40:43], s60 offen offset:1024 lds
    s_mov_b32 s40, s14
    s_and_b32 s41, s15, 0xffff
    s_mov_b32 s42, 8192
    s_mov_b32 s43, 0x20000
    s_mov_b32 m0, 125056
    s_mov_b32 s60, 0
    buffer_load_dwordx4 v9, s[40:43], s60 offen offset:0 lds
    buffer_load_dwordx4 v9, s[40:43], s60 offen offset:1024 lds
    buffer_load_dwordx4 v9, s[40:43], s60 offen offset:2048 lds
    buffer_load_dwordx4 v9, s[40:43], s60 offen offset:3072 lds
    s_mov_b32 m0, 129152
    s_mov_b32 s60, 4096
    buffer_load_dwordx4 v9, s[40:43], s60 offen offset:0 lds
    buffer_load_dwordx4 v9, s[40:43], s60 offen offset:1024 lds
    buffer_load_dwordx4 v9, s[40:43], s60 offen offset:2048 lds
    buffer_load_dwordx4 v9, s[40:43], s60 offen offset:3072 lds
    s_mov_b32 s40, s12
    s_and_b32 s41, s13, 0xffff
    s_mov_b32 s42, 8192
    s_mov_b32 s43, 0x20000
    s_mov_b32 m0, 133248
    s_mov_b32 s60, 0
    buffer_load_dwordx4 v9, s[40:43], s60 offen offset:0 lds
    buffer_load_dwordx4 v9, s[40:43], s60 offen offset:1024 lds
    buffer_load_dwordx4 v9, s[40:43], s60 offen offset:2048 lds
    buffer_load_dwordx4 v9, s[40:43], s60 offen offset:3072 lds
    s_mov_b32 m0, 137344
    s_mov_b32 s60, 4096
    buffer_load_dwordx4 v9, s[40:43], s60 offen offset:0 lds
    buffer_load_dwordx4 v9, s[40:43], s60 offen offset:1024 lds
    buffer_load_dwordx4 v9, s[40:43], s60 offen offset:2048 lds
    buffer_load_dwordx4 v9, s[40:43], s60 offen offset:3072 lds
    s_mov_b32 m0, 67712
    s_mov_b32 s60, 0
    buffer_load_dwordx4 v236, s[24:27], s60 offen offset:0 lds
    buffer_load_dwordx4 v238, s[24:27], s60 offen offset:1024 lds
    buffer_load_dwordx4 v240, s[24:27], s60 offen offset:2048 lds
    buffer_load_dwordx4 v242, s[24:27], s60 offen offset:3072 lds
    s_mov_b32 m0, 71808
    s_mov_b32 s60, 1048576
    buffer_load_dwordx4 v236, s[24:27], s60 offen offset:0 lds
    buffer_load_dwordx4 v238, s[24:27], s60 offen offset:1024 lds
    buffer_load_dwordx4 v240, s[24:27], s60 offen offset:2048 lds
    buffer_load_dwordx4 v242, s[24:27], s60 offen offset:3072 lds
    s_mov_b32 m0, 75904
    s_mov_b32 s60, 2097152
    buffer_load_dwordx4 v236, s[24:27], s60 offen offset:0 lds
    buffer_load_dwordx4 v238, s[24:27], s60 offen offset:1024 lds
    buffer_load_dwordx4 v240, s[24:27], s60 offen offset:2048 lds
    buffer_load_dwordx4 v242, s[24:27], s60 offen offset:3072 lds
    s_mov_b32 m0, 80000
    s_mov_b32 s60, 3145728
    buffer_load_dwordx4 v236, s[24:27], s60 offen offset:0 lds
    buffer_load_dwordx4 v238, s[24:27], s60 offen offset:1024 lds
    buffer_load_dwordx4 v240, s[24:27], s60 offen offset:2048 lds
    buffer_load_dwordx4 v242, s[24:27], s60 offen offset:3072 lds
NORAW2:
    s_mov_b32 m0, s3
    s_waitcnt vmcnt(0)
    s_barrier
    v_bfe_u32 v17, v1, 2, 2
    v_and_b32 v18, 3, v1
    v_lshlrev_b32 v18, 3, v18
    v_lshl_add_u32 v18, v17, 7, v18
    s_and_b32 s60, s48, 1
    s_lshr_b32 s61, s48, 1
    s_lshl_b32 s62, s60, 12
    s_lshl_b32 s61, s61, 5
    s_add_u32 s61, s61, s62
    s_add_u32 s61, s61, 100480
    v_lshl_add_u32 v17, v11, 10, v18
    v_add_u32 v17, s61, v17
    s_lshl_b32 s61, s60, 6
    s_add_u32 s61, s61, 116864
    v_lshl_add_u32 v18, v11, 9, v18
    v_add_u32 v18, s61, v18
    ds_read_b64_tr_b16 v[120:121], v17 offset:8192
    ds_read_b64_tr_b16 v[122:123], v17 offset:8704
    ds_read_b64_tr_b16 v[124:125], v18
    ds_read_b64_tr_b16 v[126:127], v18 offset:32
    ds_read_b64_tr_b16 v[128:129], v17 offset:24576
    ds_read_b64_tr_b16 v[130:131], v17 offset:25088
    ds_read_b64_tr_b16 v[132:133], v17
    ds_read_b64_tr_b16 v[134:135], v17 offset:512
    ds_read_b64_tr_b16 v[136:137], v17 offset:32768
    ds_read_b64_tr_b16 v[138:139], v17 offset:33280
    s_lshl_b32 s61, s48, 10
    s_add_u32 s62, s61, 142976
    v_add_u32 v17, s62, v9
    s_add_u32 s62, s61, 84096
    v_add_u32 v18, s62, v9
    s_lshl_b32 s62, s60, 10
    s_add_u32 s62, s62, 159360
    v_add_u32 v19, s62, v9
    s_mov_b32 s62, 0xbfb8aa3b
    s_waitcnt lgkmcnt(6)
    v_lshlrev_b32 v152, 16, v120
    v_and_b32 v153, 0xffff0000, v120
    v_lshlrev_b32 v154, 16, v121
    v_and_b32 v155, 0xffff0000, v121
    v_lshlrev_b32 v156, 16, v122
    v_and_b32 v157, 0xffff0000, v122
    v_lshlrev_b32 v158, 16, v123
    v_and_b32 v159, 0xffff0000, v123
    v_lshlrev_b32 v160, 16, v124
    v_and_b32 v161, 0xffff0000, v124
    v_lshlrev_b32 v162, 16, v125
    v_and_b32 v163, 0xffff0000, v125
    v_lshlrev_b32 v164, 16, v126
    v_and_b32 v165, 0xffff0000, v126
    v_lshlrev_b32 v166, 16, v127
    v_and_b32 v167, 0xffff0000, v127
    v_mul_f32 v152, s62, v152
    v_mul_f32 v153, s62, v153
    v_mul_f32 v154, s62, v154
    v_mul_f32 v155, s62, v155
    v_mul_f32 v156, s62, v156
    v_mul_f32 v157, s62, v157
    v_mul_f32 v158, s62, v158
    v_mul_f32 v159, s62, v159
    v_mul_f32 v160, s62, v160
    v_mul_f32 v161, s62, v161
    v_mul_f32 v162, s62, v162
    v_mul_f32 v163, s62, v163
    v_mul_f32 v164, s62, v164
    v_mul_f32 v165, s62, v165
    v_mul_f32 v166, s62, v166
    v_mul_f32 v167, s62, v167
    v_cvt_pk_bf16_f32 v120, v152, v153
    v_cvt_pk_bf16_f32 v121, v154, v155
    v_cvt_pk_bf16_f32 v122, v156, v157
    v_cvt_pk_bf16_f32 v123, v158, v159
    v_cvt_pk_bf16_f32 v124, v160, v161
    v_cvt_pk_bf16_f32 v125, v162, v163
    v_cvt_pk_bf16_f32 v126, v164, v165
    v_cvt_pk_bf16_f32 v127, v166, v167
    ds_write_b128 v17, v[120:123]
    ds_write_b128 v19, v[124:127]
    s_waitcnt lgkmcnt(2)
    ds_write_b128 v17, v[128:131] offset:8192
    ds_write_b128 v18, v[132:135]
    ds_write_b128 v18, v[136:139] offset:8192
    s_waitcnt lgkmcnt(0)
    s_barrier
    s_lshr_b32 s60, s48, 1
    s_and_b32 s61, s48, 1
    s_lshl_b32 s62, s60, 12
    s_add_u32 s62, s62, 67712
    v_add_u32 v30, s62, v8
    v_xor_b32 v31, 64, v30
    s_lshl_b32 s62, s61, 12
    s_add_u32 s62, s62, 84096
    v_add_u32 v29, s62, v9
    ds_read_b128 v[184:187], v30 offset:0
    ds_read_b128 v[188:191], v31 offset:0
    ds_read_b128 v[192:195], v30 offset:1024
    ds_read_b128 v[196:199], v31 offset:1024
    ds_read_b128 v[152:155], v29 offset:0
    ds_read_b128 v[156:159], v29 offset:1024
    ds_read_b128 v[160:163], v29 offset:2048
    ds_read_b128 v[164:167], v29 offset:3072
    ds_read_b128 v[168:171], v29 offset:8192
    ds_read_b128 v[172:175], v29 offset:9216
    ds_read_b128 v[176:179], v29 offset:10240
    ds_read_b128 v[180:183], v29 offset:11264
    s_waitcnt lgkmcnt(0)
    s_barrier
    s_lshr_b32 s60, s48, 1
    s_and_b32 s61, s48, 1
    s_mul_i32 s62, s60, 24576
    s_movk_i32 s63, 6144
    v_mad_u32_u24 v25, v11, s63, v6
    v_add_u32 v25, s62, v25
    s_lshl_b32 s62, s61, 7
    v_add_u32 v24, s62, v25
    v_add_u32 v25, s62, v24
    v_mfma_f32_16x16x32_bf16 v[120:123], v[184:187], v[152:155], 0
    v_mfma_f32_16x16x32_bf16 v[124:127], v[192:195], v[152:155], 0
    v_mfma_f32_16x16x32_bf16 v[128:131], v[184:187], v[160:163], 0
    v_mfma_f32_16x16x32_bf16 v[132:135], v[192:195], v[160:163], 0
    v_mfma_f32_16x16x32_bf16 v[120:123], v[188:191], v[156:159], v[120:123]
    v_mfma_f32_16x16x32_bf16 v[124:127], v[196:199], v[156:159], v[124:127]
    v_mfma_f32_16x16x32_bf16 v[128:131], v[188:191], v[164:167], v[128:131]
    v_mfma_f32_16x16x32_bf16 v[132:135], v[196:199], v[164:167], v[132:135]
    v_mfma_f32_16x16x32_bf16 v[136:139], v[184:187], v[168:171], 0
    v_mfma_f32_16x16x32_bf16 v[140:143], v[192:195], v[168:171], 0
    v_mfma_f32_16x16x32_bf16 v[144:147], v[184:187], v[176:179], 0
    v_mfma_f32_16x16x32_bf16 v[148:151], v[192:195], v[176:179], 0
    v_mfma_f32_16x16x32_bf16 v[136:139], v[188:191], v[172:175], v[136:139]
    v_mfma_f32_16x16x32_bf16 v[140:143], v[196:199], v[172:175], v[140:143]
    v_mfma_f32_16x16x32_bf16 v[144:147], v[188:191], v[180:183], v[144:147]
    v_mfma_f32_16x16x32_bf16 v[148:151], v[196:199], v[180:183], v[148:151]
    s_cmp_lt_u32 s48, 6
    s_cbranch_scc1 PU_FULLB
    s_mov_b64 exec, 0xffff
PU_FULLB:
    s_mov_b32 s62, 0xbfb8aa3b
    v_mul_f32 v120, s62, v120
    v_mul_f32 v128, s62, v128
    v_and_b32 v154, 0xffff0000, v120
    v_and_b32 v155, 0xffff0000, v128
    v_sub_f32 v120, v120, v154
    v_sub_f32 v128, v128, v155
    v_cvt_pk_bf16_f32 v152, v154, v120
    v_cvt_pk_bf16_f32 v153, v155, v128
    ds_write_b64 v24, v[152:153] offset:512
    v_mul_f32 v124, s62, v124
    v_mul_f32 v132, s62, v132
    v_and_b32 v158, 0xffff0000, v124
    v_and_b32 v159, 0xffff0000, v132
    v_sub_f32 v124, v124, v158
    v_sub_f32 v132, v132, v159
    v_cvt_pk_bf16_f32 v156, v158, v124
    v_cvt_pk_bf16_f32 v157, v159, v132
    ds_write_b64 v24, v[156:157] offset:1280
    v_cvt_f64_f32 v[160:161], v136
    v_cvt_f64_f32 v[162:163], v144
    ds_write_b64 v25, v[160:161] offset:0
    ds_write_b64 v25, v[162:163] offset:128
    v_cvt_f64_f32 v[164:165], v140
    v_cvt_f64_f32 v[166:167], v148
    ds_write_b64 v25, v[164:165] offset:768
    ds_write_b64 v25, v[166:167] offset:896
    s_cmp_ge_u32 s48, 6
    s_cbranch_scc1 PU_DONEB
    v_mul_f32 v121, s62, v121
    v_mul_f32 v129, s62, v129
    v_and_b32 v170, 0xffff0000, v121
    v_and_b32 v171, 0xffff0000, v129
    v_sub_f32 v121, v121, v170
    v_sub_f32 v129, v129, v171
    v_cvt_pk_bf16_f32 v168, v170, v121
    v_cvt_pk_bf16_f32 v169, v171, v129
    ds_write_b64 v24, v[168:169] offset:3584
    v_mul_f32 v125, s62, v125
    v_mul_f32 v133, s62, v133
    v_and_b32 v174, 0xffff0000, v125
    v_and_b32 v175, 0xffff0000, v133
    v_sub_f32 v125, v125, v174
    v_sub_f32 v133, v133, v175
    v_cvt_pk_bf16_f32 v172, v174, v125
    v_cvt_pk_bf16_f32 v173, v175, v133
    ds_write_b64 v24, v[172:173] offset:4352
    v_cvt_f64_f32 v[176:177], v137
    v_cvt_f64_f32 v[178:179], v145
    ds_write_b64 v25, v[176:177] offset:3072
    ds_write_b64 v25, v[178:179] offset:3200
    v_cvt_f64_f32 v[180:181], v141
    v_cvt_f64_f32 v[182:183], v149
    ds_write_b64 v25, v[180:181] offset:3840
    ds_write_b64 v25, v[182:183] offset:3968
    v_mul_f32 v122, s62, v122
    v_mul_f32 v130, s62, v130
    v_and_b32 v154, 0xffff0000, v122
    v_and_b32 v155, 0xffff0000, v130
    v_sub_f32 v122, v122, v154
    v_sub_f32 v130, v130, v155
    v_cvt_pk_bf16_f32 v152, v154, v122
    v_cvt_pk_bf16_f32 v153, v155, v130
    ds_write_b64 v24, v[152:153] offset:2048
    v_mul_f32 v126, s62, v126
    v_mul_f32 v134, s62, v134
    v_and_b32 v158, 0xffff0000, v126
    v_and_b32 v159, 0xffff0000, v134
    v_sub_f32 v126, v126, v158
    v_sub_f32 v134, v134, v159
    v_cvt_pk_bf16_f32 v156, v158, v126
    v_cvt_pk_bf16_f32 v157, v159, v134
    ds_write_b64 v24, v[156:157] offset:2816
    v_cvt_f64_f32 v[160:161], v138
    v_cvt_f64_f32 v[162:163], v146
    ds_write_b64 v25, v[160:161] offset:1536
    ds_write_b64 v25, v[162:163] offset:1664
    v_cvt_f64_f32 v[164:165], v142
    v_cvt_f64_f32 v[166:167], v150
    ds_write_b64 v25, v[164:165] offset:2304
    ds_write_b64 v25, v[166:167] offset:2432
    v_mul_f32 v123, s62, v123
    v_mul_f32 v131, s62, v131
    v_and_b32 v170, 0xffff0000, v123
    v_and_b32 v171, 0xffff0000, v131
    v_sub_f32 v123, v123, v170
    v_sub_f32 v131, v131, v171
    v_cvt_pk_bf16_f32 v168, v170, v123
    v_cvt_pk_bf16_f32 v169, v171, v131
    ds_write_b64 v24, v[168:169] offset:5120
    v_mul_f32 v127, s62, v127
    v_mul_f32 v135, s62, v135
    v_and_b32 v174, 0xffff0000, v127
    v_and_b32 v175, 0xffff0000, v135
    v_sub_f32 v127, v127, v174
    v_sub_f32 v135, v135, v175
    v_cvt_pk_bf16_f32 v172, v174, v127
    v_cvt_pk_bf16_f32 v173, v175, v135
    ds_write_b64 v24, v[172:173] offset:5888
    v_cvt_f64_f32 v[176:177], v139
    v_cvt_f64_f32 v[178:179], v147
    ds_write_b64 v25, v[176:177] offset:4608
    ds_write_b64 v25, v[178:179] offset:4736
    v_cvt_f64_f32 v[180:181], v143
    v_cvt_f64_f32 v[182:183], v151
    ds_write_b64 v25, v[180:181] offset:5376
    ds_write_b64 v25, v[182:183] offset:5504
PU_DONEB:
    s_mov_b64 exec, -1
PASS:
    v_mov_b32 v20, -1
    v_mov_b32 v21, 0xffff
    v_mov_b32 v22, -1
    v_mov_b32 v23, 0xffff
    v_lshlrev_b32 v24, 4, v0
    ds_write_b128 v24, v[20:23] offset:2176
    ds_write_b128 v24, v[20:23] offset:10368
    ds_write_b128 v24, v[20:23] offset:18560
    ds_write_b128 v24, v[20:23] offset:26752
    v_mov_b32 v26, 0
    v_mov_b32 v27, 0
    v_lshlrev_b32 v25, 3, v0
    v_min_u32 v25, 2152, v25
    ds_write_b64 v25, v[26:27] offset:16
    s_lshl_b32 s60, s48, 8
    v_lshl_add_u32 v3, v5, 3, s60
    v_lshl_add_u32 v4, v11, 6, s60
    v_lshrrev_b32 v21, 3, v1
    v_lshl_add_u32 v2, v21, 5, s60
    s_lshl_b32 s60, s48, 5
    v_add_u32 v28, s60, v1
    s_movk_i32 s61, 2176
    v_mul_u32_u24 v28, s61, v28
    s_waitcnt lgkmcnt(0)
    s_barrier
TPOLL:
    s_lshl_b32 s62, s57, 3
    s_mov_b32 exec_hi, 0
    buffer_load_dwordx2 v[104:105], v28, s[36:39], s62 offen sc1
    s_mov_b32 exec_hi, -1
    s_branch TPW
MAIN_SAFE:
    v_mov_b32 v244, 0
    v_mov_b32 v245, 0
    v_mov_b32 v246, 0
    v_mov_b32 v247, 0
    v_mov_b32 v26, v22
    v_mov_b32 v27, v23
    s_setprio 1
    v_mfma_f32_16x16x32_bf16 v[120:123], v[200:203], v[98:101], 0
    v_mfma_f32_16x16x32_bf16 v[120:123], v[184:187], v[32:35], v[120:123]
    v_mfma_f32_16x16x32_bf16 v[120:123], v[188:191], v[36:39], v[120:123]
    v_mfma_f32_16x16x32_bf16 v[124:127], v[204:207], v[96:99], 0
    v_mfma_f32_16x16x32_bf16 v[124:127], v[192:195], v[32:35], v[124:127]
    v_mfma_f32_16x16x32_bf16 v[124:127], v[196:199], v[36:39], v[124:127]
    v_mfma_f32_16x16x32_bf16 v[128:131], v[200:203], v[104:107], 0
    v_mfma_f32_16x16x32_bf16 v[128:131], v[184:187], v[40:43], v[128:131]
    v_mfma_f32_16x16x32_bf16 v[128:131], v[188:191], v[44:47], v[128:131]
    v_mfma_f32_16x16x32_bf16 v[132:135], v[204:207], v[102:105], 0
    v_mfma_f32_16x16x32_bf16 v[132:135], v[192:195], v[40:43], v[132:135]
    v_mfma_f32_16x16x32_bf16 v[132:135], v[196:199], v[44:47], v[132:135]
    v_mfma_f32_16x16x32_bf16 v[152:155], v[184:187], v[64:67], 0
    v_mfma_f32_16x16x32_bf16 v[152:155], v[188:191], v[68:71], v[152:155]
    v_mfma_f32_16x16x32_bf16 v[156:159], v[192:195], v[64:67], 0
    v_mfma_f32_16x16x32_bf16 v[156:159], v[196:199], v[68:71], v[156:159]
    v_mfma_f32_16x16x32_bf16 v[160:163], v[184:187], v[72:75], 0
    v_mfma_f32_16x16x32_bf16 v[160:163], v[188:191], v[76:79], v[160:163]
    v_mfma_f32_16x16x32_bf16 v[164:167], v[192:195], v[72:75], 0
    v_mfma_f32_16x16x32_bf16 v[164:167], v[196:199], v[76:79], v[164:167]
    s_setprio 0
    buffer_load_dwordx4 v[214:217], v[248:249], s[28:31], 0 idxen offen
    ds_read_u16 v16, v4 offset:4230
    ds_read_u16 v17, v4 offset:4262
    ds_read_b128 v[236:239], v2 offset:6272
    ds_read_b128 v[240:243], v2 offset:6288
    s_waitcnt lgkmcnt(0)
    s_nop 7
    s_setprio 1
    v_mfma_f32_16x16x32_bf16 v[136:139], v[200:203], v[110:113], 0
    v_mad_u32_u24 v24, v16, s11, v6
    v_mad_u32_u24 v25, v17, s11, v6
    v_mfma_f32_16x16x32_bf16 v[136:139], v[184:187], v[48:51], v[136:139]
    v_mad_u32_u16 v236, v237, s55, v250
    v_mad_u32_u16 v238, v239, s55, v251
    v_mfma_f32_16x16x32_bf16 v[136:139], v[188:191], v[52:55], v[136:139]
    v_mad_u32_u16 v240, v241, s55, v252
    v_mad_u32_u16 v242, v243, s55, v253
    v_mfma_f32_16x16x32_bf16 v[140:143], v[204:207], v[108:111], 0
    v_exp_f32 v120, v120
    v_mfma_f32_16x16x32_bf16 v[140:143], v[192:195], v[48:51], v[140:143]
    v_exp_f32 v121, v121
    v_mfma_f32_16x16x32_bf16 v[140:143], v[196:199], v[52:55], v[140:143]
    v_exp_f32 v122, v122
    v_mfma_f32_16x16x32_bf16 v[144:147], v[200:203], v[116:119], 0
    v_exp_f32 v123, v123
    v_mfma_f32_16x16x32_bf16 v[144:147], v[184:187], v[56:59], v[144:147]
    v_exp_f32 v124, v124
    v_mfma_f32_16x16x32_bf16 v[144:147], v[188:191], v[60:63], v[144:147]
    v_exp_f32 v125, v125
    v_mfma_f32_16x16x32_bf16 v[148:151], v[204:207], v[114:117], 0
    v_exp_f32 v126, v126
    v_mfma_f32_16x16x32_bf16 v[148:151], v[192:195], v[56:59], v[148:151]
    v_exp_f32 v127, v127
    v_mfma_f32_16x16x32_bf16 v[148:151], v[196:199], v[60:63], v[148:151]
    v_exp_f32 v128, v128
    v_mfma_f32_16x16x32_bf16 v[168:171], v[184:187], v[80:83], 0
    v_exp_f32 v129, v129
    v_mfma_f32_16x16x32_bf16 v[168:171], v[188:191], v[84:87], v[168:171]
    v_exp_f32 v130, v130
    v_mfma_f32_16x16x32_bf16 v[172:175], v[192:195], v[80:83], 0
    v_exp_f32 v131, v131
    v_mfma_f32_16x16x32_bf16 v[172:175], v[196:199], v[84:87], v[172:175]
    v_exp_f32 v132, v132
    v_mfma_f32_16x16x32_bf16 v[176:179], v[184:187], v[88:91], 0
    v_exp_f32 v133, v133
    v_mfma_f32_16x16x32_bf16 v[176:179], v[188:191], v[92:95], v[176:179]
    v_exp_f32 v134, v134
    v_mfma_f32_16x16x32_bf16 v[180:183], v[192:195], v[88:91], 0
    v_exp_f32 v135, v135
    v_mfma_f32_16x16x32_bf16 v[180:183], v[196:199], v[92:95], v[180:183]
    s_setprio 0
    s_waitcnt vmcnt(1)
    ds_read_b128 v[184:187], v12 offset:0
    ds_read_b128 v[188:191], v13 offset:0
    ds_read_b128 v[192:195], v12 offset:1024
    ds_read_b128 v[196:199], v13 offset:1024
    ds_read_b32 v248, v3 offset:8320
    ds_read_b32 v98, v24 offset:512
    ds_read_b32 v99, v25 offset:512
    ds_read_b32 v104, v24 offset:516
    ds_read_b32 v105, v25 offset:516
    s_waitcnt lgkmcnt(5)
    buffer_load_dwordx4 v236, s[24:27], 0 offen offset:0 lds
    buffer_load_dwordx4 v238, s[24:27], 0 offen offset:1024 lds
    buffer_load_dwordx4 v240, s[24:27], 0 offen offset:2048 lds
    buffer_load_dwordx4 v242, s[24:27], 0 offen offset:3072 lds
    s_sub_u32 s51, s51, 1
    s_cmp_eq_u32 s51, 0
    s_waitcnt lgkmcnt(0)
    v_permlane16_swap_b32 v208, v210
    v_permlane16_swap_b32 v209, v211
    v_pk_add_f32 v[120:121], v[120:121], 1.0 op_sel_hi:[1,0]
    v_pk_add_f32 v[122:123], v[122:123], 1.0 op_sel_hi:[1,0]
    v_pk_add_f32 v[124:125], v[124:125], 1.0 op_sel_hi:[1,0]
    v_pk_add_f32 v[126:127], v[126:127], 1.0 op_sel_hi:[1,0]
    v_pk_add_f32 v[128:129], v[128:129], 1.0 op_sel_hi:[1,0]
    v_pk_add_f32 v[130:131], v[130:131], 1.0 op_sel_hi:[1,0]
    v_pk_add_f32 v[132:133], v[132:133], 1.0 op_sel_hi:[1,0]
    v_pk_add_f32 v[134:135], v[134:135], 1.0 op_sel_hi:[1,0]
    v_rcp_f32 v120, v120
    v_rcp_f32 v121, v121
    v_rcp_f32 v122, v122
    v_rcp_f32 v123, v123
    v_rcp_f32 v124, v124
    v_rcp_f32 v125, v125
    v_rcp_f32 v126, v126
    v_rcp_f32 v127, v127
    v_rcp_f32 v128, v128
    v_rcp_f32 v129, v129
    v_rcp_f32 v130, v130
    v_rcp_f32 v131, v131
    v_rcp_f32 v132, v132
    v_rcp_f32 v133, v133
    v_rcp_f32 v134, v134
    v_rcp_f32 v135, v135
    v_pk_mul_f32 v[220:221], v[152:153], v[120:121]
    v_pk_mul_f32 v[222:223], v[160:161], v[128:129]
    v_pk_fma_f32 v[220:221], v[154:155], v[122:123], v[220:221]
    v_pk_fma_f32 v[222:223], v[162:163], v[130:131], v[222:223]
    v_pk_fma_f32 v[220:221], v[156:157], v[124:125], v[220:221]
    v_pk_fma_f32 v[222:223], v[164:165], v[132:133], v[222:223]
    v_pk_fma_f32 v[220:221], v[158:159], v[126:127], v[220:221]
    v_pk_fma_f32 v[222:223], v[166:167], v[134:135], v[222:223]
    s_cbranch_scc1 FINS_1
    .p2align 6
LOOPS:
    s_setprio 1
    v_mfma_f32_16x16x32_bf16 v[120:123], v[206:209], v[98:101], 0
    v_cvt_f64_f32 v[228:229], v244
    v_cvt_f64_f32 v[230:231], v245
    v_mfma_f32_16x16x32_bf16 v[120:123], v[184:187], v[32:35], v[120:123]
    v_cvt_f64_f32 v[232:233], v246
    v_cvt_f64_f32 v[234:235], v247
    v_mfma_f32_16x16x32_bf16 v[120:123], v[188:191], v[36:39], v[120:123]
    v_exp_f32 v136, v136
    v_mfma_f32_16x16x32_bf16 v[124:127], v[210:213], v[96:99], 0
    v_exp_f32 v137, v137
    v_mfma_f32_16x16x32_bf16 v[124:127], v[192:195], v[32:35], v[124:127]
    v_exp_f32 v138, v138
    v_mfma_f32_16x16x32_bf16 v[124:127], v[196:199], v[36:39], v[124:127]
    v_exp_f32 v139, v139
    v_mfma_f32_16x16x32_bf16 v[128:131], v[206:209], v[104:107], 0
    v_exp_f32 v140, v140
    v_mfma_f32_16x16x32_bf16 v[128:131], v[184:187], v[40:43], v[128:131]
    v_exp_f32 v141, v141
    v_mfma_f32_16x16x32_bf16 v[128:131], v[188:191], v[44:47], v[128:131]
    v_exp_f32 v142, v142
    v_mfma_f32_16x16x32_bf16 v[132:135], v[210:213], v[102:105], 0
    v_exp_f32 v143, v143
    v_mfma_f32_16x16x32_bf16 v[132:135], v[192:195], v[40:43], v[132:135]
    v_exp_f32 v144, v144
    v_mfma_f32_16x16x32_bf16 v[132:135], v[196:199], v[44:47], v[132:135]
    v_exp_f32 v145, v145
    v_mfma_f32_16x16x32_bf16 v[152:155], v[184:187], v[64:67], 0
    v_exp_f32 v146, v146
    v_mfma_f32_16x16x32_bf16 v[152:155], v[188:191], v[68:71], v[152:155]
    v_exp_f32 v147, v147
    v_mfma_f32_16x16x32_bf16 v[156:159], v[192:195], v[64:67], 0
    v_exp_f32 v148, v148
    v_mfma_f32_16x16x32_bf16 v[156:159], v[196:199], v[68:71], v[156:159]
    v_exp_f32 v149, v149
    v_mfma_f32_16x16x32_bf16 v[160:163], v[184:187], v[72:75], 0
    v_exp_f32 v150, v150
    v_mfma_f32_16x16x32_bf16 v[160:163], v[188:191], v[76:79], v[160:163]
    v_exp_f32 v151, v151
    v_mfma_f32_16x16x32_bf16 v[164:167], v[192:195], v[72:75], 0
    v_mfma_f32_16x16x32_bf16 v[164:167], v[196:199], v[76:79], v[164:167]
    s_setprio 0
    buffer_load_dwordx4 v[202:205], v[248:249], s[28:31], 0 idxen offen
    ds_read_u16 v16, v4 offset:6278
    ds_read_u16 v17, v4 offset:6310
    ds_read_b128 v[236:239], v2 offset:8320
    ds_read_b128 v[240:243], v2 offset:8336
    ds_add_f64 v26, v[228:229] offset:256
    ds_add_f64 v27, v[230:231] offset:256
    ds_add_f64 v26, v[232:233] offset:384
    ds_add_f64 v27, v[234:235] offset:384
    ds_read_b32 v110, v24 offset:640
    ds_read_b32 v111, v25 offset:640
    ds_read_b32 v116, v24 offset:644
    ds_read_b32 v117, v25 offset:644
    s_waitcnt lgkmcnt(0)
    v_pk_mul_f32 v[244:245], v[220:221], 1.0 op_sel_hi:[1,0]
    v_pk_mul_f32 v[246:247], v[222:223], 1.0 op_sel_hi:[1,0]
    v_pk_add_f32 v[136:137], v[136:137], 1.0 op_sel_hi:[1,0]
    v_pk_add_f32 v[138:139], v[138:139], 1.0 op_sel_hi:[1,0]
    v_pk_add_f32 v[140:141], v[140:141], 1.0 op_sel_hi:[1,0]
    v_pk_add_f32 v[142:143], v[142:143], 1.0 op_sel_hi:[1,0]
    v_pk_add_f32 v[144:145], v[144:145], 1.0 op_sel_hi:[1,0]
    v_pk_add_f32 v[146:147], v[146:147], 1.0 op_sel_hi:[1,0]
    v_pk_add_f32 v[148:149], v[148:149], 1.0 op_sel_hi:[1,0]
    v_pk_add_f32 v[150:151], v[150:151], 1.0 op_sel_hi:[1,0]
    v_rcp_f32 v136, v136
    v_rcp_f32 v137, v137
    v_rcp_f32 v138, v138
    v_rcp_f32 v139, v139
    v_rcp_f32 v140, v140
    v_rcp_f32 v141, v141
    v_rcp_f32 v142, v142
    v_rcp_f32 v143, v143
    v_rcp_f32 v144, v144
    v_rcp_f32 v145, v145
    v_rcp_f32 v146, v146
    v_rcp_f32 v147, v147
    v_rcp_f32 v148, v148
    v_rcp_f32 v149, v149
    v_rcp_f32 v150, v150
    v_rcp_f32 v151, v151
    v_pk_mul_f32 v[220:221], v[168:169], v[136:137]
    v_pk_mul_f32 v[222:223], v[176:177], v[144:145]
    v_pk_fma_f32 v[220:221], v[170:171], v[138:139], v[220:221]
    v_pk_fma_f32 v[222:223], v[178:179], v[146:147], v[222:223]
    v_pk_fma_f32 v[220:221], v[172:173], v[140:141], v[220:221]
    v_pk_fma_f32 v[222:223], v[180:181], v[148:149], v[222:223]
    v_pk_fma_f32 v[220:221], v[174:175], v[142:143], v[220:221]
    v_pk_fma_f32 v[222:223], v[182:183], v[150:151], v[222:223]
    s_setprio 1
    v_mfma_f32_16x16x32_bf16 v[136:139], v[206:209], v[110:113], 0
    v_cvt_f64_f32 v[228:229], v244
    v_cvt_f64_f32 v[230:231], v245
    v_mfma_f32_16x16x32_bf16 v[136:139], v[184:187], v[48:51], v[136:139]
    v_cvt_f64_f32 v[232:233], v246
    v_cvt_f64_f32 v[234:235], v247
    v_mfma_f32_16x16x32_bf16 v[136:139], v[188:191], v[52:55], v[136:139]
    v_mad_u32_u24 v26, v16, s11, v6
    v_mad_u32_u24 v27, v17, s11, v6
    v_mfma_f32_16x16x32_bf16 v[140:143], v[210:213], v[108:111], 0
    v_mad_u32_u16 v236, v237, s55, v250
    v_mad_u32_u16 v238, v239, s55, v251
    v_mfma_f32_16x16x32_bf16 v[140:143], v[192:195], v[48:51], v[140:143]
    v_mad_u32_u16 v240, v241, s55, v252
    v_mad_u32_u16 v242, v243, s55, v253
    v_mfma_f32_16x16x32_bf16 v[140:143], v[196:199], v[52:55], v[140:143]
    v_exp_f32 v120, v120
    v_mfma_f32_16x16x32_bf16 v[144:147], v[206:209], v[116:119], 0
    v_exp_f32 v121, v121
    v_mfma_f32_16x16x32_bf16 v[144:147], v[184:187], v[56:59], v[144:147]
    v_exp_f32 v122, v122
    v_mfma_f32_16x16x32_bf16 v[144:147], v[188:191], v[60:63], v[144:147]
    v_exp_f32 v123, v123
    v_mfma_f32_16x16x32_bf16 v[148:151], v[210:213], v[114:117], 0
    v_exp_f32 v124, v124
    v_mfma_f32_16x16x32_bf16 v[148:151], v[192:195], v[56:59], v[148:151]
    v_exp_f32 v125, v125
    v_mfma_f32_16x16x32_bf16 v[148:151], v[196:199], v[60:63], v[148:151]
    v_exp_f32 v126, v126
    v_mfma_f32_16x16x32_bf16 v[168:171], v[184:187], v[80:83], 0
    v_exp_f32 v127, v127
    v_mfma_f32_16x16x32_bf16 v[168:171], v[188:191], v[84:87], v[168:171]
    v_exp_f32 v128, v128
    v_mfma_f32_16x16x32_bf16 v[172:175], v[192:195], v[80:83], 0
    v_exp_f32 v129, v129
    v_mfma_f32_16x16x32_bf16 v[172:175], v[196:199], v[84:87], v[172:175]
    v_exp_f32 v130, v130
    v_mfma_f32_16x16x32_bf16 v[176:179], v[184:187], v[88:91], 0
    v_exp_f32 v131, v131
    v_mfma_f32_16x16x32_bf16 v[176:179], v[188:191], v[92:95], v[176:179]
    v_exp_f32 v132, v132
    v_mfma_f32_16x16x32_bf16 v[180:183], v[192:195], v[88:91], 0
    v_exp_f32 v133, v133
    v_mfma_f32_16x16x32_bf16 v[180:183], v[196:199], v[92:95], v[180:183]
    v_exp_f32 v134, v134
    v_exp_f32 v135, v135
    s_setprio 0
    s_waitcnt vmcnt(1)
    ds_read_b128 v[184:187], v12 offset:0
    ds_read_b128 v[188:191], v13 offset:0
    ds_read_b128 v[192:195], v12 offset:1024
    ds_read_b128 v[196:199], v13 offset:1024
    ds_read_b32 v248, v3 offset:10368
    ds_add_f64 v22, v[228:229] offset:0
    ds_add_f64 v23, v[230:231] offset:0
    ds_add_f64 v22, v[232:233] offset:128
    ds_add_f64 v23, v[234:235] offset:128
    ds_read_b32 v98, v26 offset:512
    ds_read_b32 v99, v27 offset:512
    ds_read_b32 v104, v26 offset:516
    ds_read_b32 v105, v27 offset:516
    s_waitcnt lgkmcnt(9)
    buffer_load_dwordx4 v236, s[24:27], 0 offen offset:0 lds
    buffer_load_dwordx4 v238, s[24:27], 0 offen offset:1024 lds
    buffer_load_dwordx4 v240, s[24:27], 0 offen offset:2048 lds
    buffer_load_dwordx4 v242, s[24:27], 0 offen offset:3072 lds
    s_sub_u32 s51, s51, 1
    s_cmp_eq_u32 s51, 0
    s_waitcnt lgkmcnt(0)
    v_permlane16_swap_b32 v214, v216
    v_permlane16_swap_b32 v215, v217
    v_pk_mul_f32 v[244:245], v[220:221], 1.0 op_sel_hi:[1,0]
    v_pk_mul_f32 v[246:247], v[222:223], 1.0 op_sel_hi:[1,0]
    v_pk_add_f32 v[120:121], v[120:121], 1.0 op_sel_hi:[1,0]
    v_pk_add_f32 v[122:123], v[122:123], 1.0 op_sel_hi:[1,0]
    v_pk_add_f32 v[124:125], v[124:125], 1.0 op_sel_hi:[1,0]
    v_pk_add_f32 v[126:127], v[126:127], 1.0 op_sel_hi:[1,0]
    v_pk_add_f32 v[128:129], v[128:129], 1.0 op_sel_hi:[1,0]
    v_pk_add_f32 v[130:131], v[130:131], 1.0 op_sel_hi:[1,0]
    v_pk_add_f32 v[132:133], v[132:133], 1.0 op_sel_hi:[1,0]
    v_pk_add_f32 v[134:135], v[134:135], 1.0 op_sel_hi:[1,0]
    v_rcp_f32 v120, v120
    v_rcp_f32 v121, v121
    v_rcp_f32 v122, v122
    v_rcp_f32 v123, v123
    v_rcp_f32 v124, v124
    v_rcp_f32 v125, v125
    v_rcp_f32 v126, v126
    v_rcp_f32 v127, v127
    v_rcp_f32 v128, v128
    v_rcp_f32 v129, v129
    v_rcp_f32 v130, v130
    v_rcp_f32 v131, v131
    v_rcp_f32 v132, v132
    v_rcp_f32 v133, v133
    v_rcp_f32 v134, v134
    v_rcp_f32 v135, v135
    v_pk_mul_f32 v[220:221], v[152:153], v[120:121]
    v_pk_mul_f32 v[222:223], v[160:161], v[128:129]
    v_pk_fma_f32 v[220:221], v[154:155], v[122:123], v[220:221]
    v_pk_fma_f32 v[222:223], v[162:163], v[130:131], v[222:223]
    v_pk_fma_f32 v[220:221], v[156:157], v[124:125], v[220:221]
    v_pk_fma_f32 v[222:223], v[164:165], v[132:133], v[222:223]
    v_pk_fma_f32 v[220:221], v[158:159], v[126:127], v[220:221]
    v_pk_fma_f32 v[222:223], v[166:167], v[134:135], v[222:223]
    s_cbranch_scc1 FINS_2
    s_setprio 1
    v_mfma_f32_16x16x32_bf16 v[120:123], v[212:215], v[98:101], 0
    v_cvt_f64_f32 v[228:229], v244
    v_cvt_f64_f32 v[230:231], v245
    v_mfma_f32_16x16x32_bf16 v[120:123], v[184:187], v[32:35], v[120:123]
    v_cvt_f64_f32 v[232:233], v246
    v_cvt_f64_f32 v[234:235], v247
    v_mfma_f32_16x16x32_bf16 v[120:123], v[188:191], v[36:39], v[120:123]
    v_exp_f32 v136, v136
    v_mfma_f32_16x16x32_bf16 v[124:127], v[216:219], v[96:99], 0
    v_exp_f32 v137, v137
    v_mfma_f32_16x16x32_bf16 v[124:127], v[192:195], v[32:35], v[124:127]
    v_exp_f32 v138, v138
    v_mfma_f32_16x16x32_bf16 v[124:127], v[196:199], v[36:39], v[124:127]
    v_exp_f32 v139, v139
    v_mfma_f32_16x16x32_bf16 v[128:131], v[212:215], v[104:107], 0
    v_exp_f32 v140, v140
    v_mfma_f32_16x16x32_bf16 v[128:131], v[184:187], v[40:43], v[128:131]
    v_exp_f32 v141, v141
    v_mfma_f32_16x16x32_bf16 v[128:131], v[188:191], v[44:47], v[128:131]
    v_exp_f32 v142, v142
    v_mfma_f32_16x16x32_bf16 v[132:135], v[216:219], v[102:105], 0
    v_exp_f32 v143, v143
    v_mfma_f32_16x16x32_bf16 v[132:135], v[192:195], v[40:43], v[132:135]
    v_exp_f32 v144, v144
    v_mfma_f32_16x16x32_bf16 v[132:135], v[196:199], v[44:47], v[132:135]
    v_exp_f32 v145, v145
    v_mfma_f32_16x16x32_bf16 v[152:155], v[184:187], v[64:67], 0
    v_exp_f32 v146, v146
    v_mfma_f32_16x16x32_bf16 v[152:155], v[188:191], v[68:71], v[152:155]
    v_exp_f32 v147, v147
    v_mfma_f32_16x16x32_bf16 v[156:159], v[192:195], v[64:67], 0
    v_exp_f32 v148, v148
    v_mfma_f32_16x16x32_bf16 v[156:159], v[196:199], v[68:71], v[156:159]
    v_exp_f32 v149, v149
    v_mfma_f32_16x16x32_bf16 v[160:163], v[184:187], v[72:75], 0
    v_exp_f32 v150, v150
    v_mfma_f32_16x16x32_bf16 v[160:163], v[188:191], v[76:79], v[160:163]
    v_exp_f32 v151, v151
    v_mfma_f32_16x16x32_bf16 v[164:167], v[192:195], v[72:75], 0
    v_mfma_f32_16x16x32_bf16 v[164:167], v[196:199], v[76:79], v[164:167]
    s_setprio 0
    buffer_load_dwordx4 v[208:211], v[248:249], s[28:31], 0 idxen offen
    ds_read_u16 v16, v4 offset:8326
    ds_read_u16 v17, v4 offset:8358
    ds_read_b128 v[236:239], v2 offset:10368
    ds_read_b128 v[240:243], v2 offset:10384
    ds_add_f64 v22, v[228:229] offset:256
    ds_add_f64 v23, v[230:231] offset:256
    ds_add_f64 v22, v[232:233] offset:384
    ds_add_f64 v23, v[234:235] offset:384
    ds_read_b32 v110, v26 offset:640
    ds_read_b32 v111, v27 offset:640
    ds_read_b32 v116, v26 offset:644
    ds_read_b32 v117, v27 offset:644
    s_waitcnt lgkmcnt(0)
    v_pk_mul_f32 v[244:245], v[220:221], 1.0 op_sel_hi:[1,0]
    v_pk_mul_f32 v[246:247], v[222:223], 1.0 op_sel_hi:[1,0]
    v_pk_add_f32 v[136:137], v[136:137], 1.0 op_sel_hi:[1,0]
    v_pk_add_f32 v[138:139], v[138:139], 1.0 op_sel_hi:[1,0]
    v_pk_add_f32 v[140:141], v[140:141], 1.0 op_sel_hi:[1,0]
    v_pk_add_f32 v[142:143], v[142:143], 1.0 op_sel_hi:[1,0]
    v_pk_add_f32 v[144:145], v[144:145], 1.0 op_sel_hi:[1,0]
    v_pk_add_f32 v[146:147], v[146:147], 1.0 op_sel_hi:[1,0]
    v_pk_add_f32 v[148:149], v[148:149], 1.0 op_sel_hi:[1,0]
    v_pk_add_f32 v[150:151], v[150:151], 1.0 op_sel_hi:[1,0]
    v_rcp_f32 v136, v136
    v_rcp_f32 v137, v137
    v_rcp_f32 v138, v138
    v_rcp_f32 v139, v139
    v_rcp_f32 v140, v140
    v_rcp_f32 v141, v141
    v_rcp_f32 v142, v142
    v_rcp_f32 v143, v143
    v_rcp_f32 v144, v144
    v_rcp_f32 v145, v145
    v_rcp_f32 v146, v146
    v_rcp_f32 v147, v147
    v_rcp_f32 v148, v148
    v_rcp_f32 v149, v149
    v_rcp_f32 v150, v150
    v_rcp_f32 v151, v151
    v_pk_mul_f32 v[220:221], v[168:169], v[136:137]
    v_pk_mul_f32 v[222:223], v[176:177], v[144:145]
    v_pk_fma_f32 v[220:221], v[170:171], v[138:139], v[220:221]
    v_pk_fma_f32 v[222:223], v[178:179], v[146:147], v[222:223]
    v_pk_fma_f32 v[220:221], v[172:173], v[140:141], v[220:221]
    v_pk_fma_f32 v[222:223], v[180:181], v[148:149], v[222:223]
    v_pk_fma_f32 v[220:221], v[174:175], v[142:143], v[220:221]
    v_pk_fma_f32 v[222:223], v[182:183], v[150:151], v[222:223]
    s_setprio 1
    v_mfma_f32_16x16x32_bf16 v[136:139], v[212:215], v[110:113], 0
    v_cvt_f64_f32 v[228:229], v244
    v_cvt_f64_f32 v[230:231], v245
    v_mfma_f32_16x16x32_bf16 v[136:139], v[184:187], v[48:51], v[136:139]
    v_cvt_f64_f32 v[232:233], v246
    v_cvt_f64_f32 v[234:235], v247
    v_mfma_f32_16x16x32_bf16 v[136:139], v[188:191], v[52:55], v[136:139]
    v_mad_u32_u24 v22, v16, s11, v6
    v_mad_u32_u24 v23, v17, s11, v6
    v_mfma_f32_16x16x32_bf16 v[140:143], v[216:219], v[108:111], 0
    v_mad_u32_u16 v236, v237, s55, v250
    v_mad_u32_u16 v238, v239, s55, v251
    v_mfma_f32_16x16x32_bf16 v[140:143], v[192:195], v[48:51], v[140:143]
    v_mad_u32_u16 v240, v241, s55, v252
    v_mad_u32_u16 v242, v243, s55, v253
    v_mfma_f32_16x16x32_bf16 v[140:143], v[196:199], v[52:55], v[140:143]
    v_exp_f32 v120, v120
    v_mfma_f32_16x16x32_bf16 v[144:147], v[212:215], v[116:119], 0
    v_exp_f32 v121, v121
    v_mfma_f32_16x16x32_bf16 v[144:147], v[184:187], v[56:59], v[144:147]
    v_exp_f32 v122, v122
    v_mfma_f32_16x16x32_bf16 v[144:147], v[188:191], v[60:63], v[144:147]
    v_exp_f32 v123, v123
    v_mfma_f32_16x16x32_bf16 v[148:151], v[216:219], v[114:117], 0
    v_exp_f32 v124, v124
    v_mfma_f32_16x16x32_bf16 v[148:151], v[192:195], v[56:59], v[148:151]
    v_exp_f32 v125, v125
    v_mfma_f32_16x16x32_bf16 v[148:151], v[196:199], v[60:63], v[148:151]
    v_exp_f32 v126, v126
    v_mfma_f32_16x16x32_bf16 v[168:171], v[184:187], v[80:83], 0
    v_exp_f32 v127, v127
    v_mfma_f32_16x16x32_bf16 v[168:171], v[188:191], v[84:87], v[168:171]
    v_exp_f32 v128, v128
    v_mfma_f32_16x16x32_bf16 v[172:175], v[192:195], v[80:83], 0
    v_exp_f32 v129, v129
    v_mfma_f32_16x16x32_bf16 v[172:175], v[196:199], v[84:87], v[172:175]
    v_exp_f32 v130, v130
    v_mfma_f32_16x16x32_bf16 v[176:179], v[184:187], v[88:91], 0
    v_exp_f32 v131, v131
    v_mfma_f32_16x16x32_bf16 v[176:179], v[188:191], v[92:95], v[176:179]
    v_exp_f32 v132, v132
    v_mfma_f32_16x16x32_bf16 v[180:183], v[192:195], v[88:91], 0
    v_exp_f32 v133, v133
    v_mfma_f32_16x16x32_bf16 v[180:183], v[196:199], v[92:95], v[180:183]
    v_exp_f32 v134, v134
    v_exp_f32 v135, v135
    s_setprio 0
    s_waitcnt vmcnt(1)
    ds_read_b128 v[184:187], v12 offset:0
    ds_read_b128 v[188:191], v13 offset:0
    ds_read_b128 v[192:195], v12 offset:1024
    ds_read_b128 v[196:199], v13 offset:1024
    ds_read_b32 v248, v3 offset:12416
    ds_add_f64 v24, v[228:229] offset:0
    ds_add_f64 v25, v[230:231] offset:0
    ds_add_f64 v24, v[232:233] offset:128
    ds_add_f64 v25, v[234:235] offset:128
    ds_read_b32 v98, v22 offset:512
    ds_read_b32 v99, v23 offset:512
    ds_read_b32 v104, v22 offset:516
    ds_read_b32 v105, v23 offset:516
    s_waitcnt lgkmcnt(9)
    buffer_load_dwordx4 v236, s[24:27], 0 offen offset:0 lds
    buffer_load_dwordx4 v238, s[24:27], 0 offen offset:1024 lds
    buffer_load_dwordx4 v240, s[24:27], 0 offen offset:2048 lds
    buffer_load_dwordx4 v242, s[24:27], 0 offen offset:3072 lds
    s_sub_u32 s51, s51, 1
    s_cmp_eq_u32 s51, 0
    s_waitcnt lgkmcnt(0)
    v_permlane16_swap_b32 v202, v204
    v_permlane16_swap_b32 v203, v205
    v_pk_mul_f32 v[244:245], v[220:221], 1.0 op_sel_hi:[1,0]
    v_pk_mul_f32 v[246:247], v[222:223], 1.0 op_sel_hi:[1,0]
    v_pk_add_f32 v[120:121], v[120:121], 1.0 op_sel_hi:[1,0]
    v_pk_add_f32 v[122:123], v[122:123], 1.0 op_sel_hi:[1,0]
    v_pk_add_f32 v[124:125], v[124:125], 1.0 op_sel_hi:[1,0]
    v_pk_add_f32 v[126:127], v[126:127], 1.0 op_sel_hi:[1,0]
    v_pk_add_f32 v[128:129], v[128:129], 1.0 op_sel_hi:[1,0]
    v_pk_add_f32 v[130:131], v[130:131], 1.0 op_sel_hi:[1,0]
    v_pk_add_f32 v[132:133], v[132:133], 1.0 op_sel_hi:[1,0]
    v_pk_add_f32 v[134:135], v[134:135], 1.0 op_sel_hi:[1,0]
    v_rcp_f32 v120, v120
    v_rcp_f32 v121, v121
    v_rcp_f32 v122, v122
    v_rcp_f32 v123, v123
    v_rcp_f32 v124, v124
    v_rcp_f32 v125, v125
    v_rcp_f32 v126, v126
    v_rcp_f32 v127, v127
    v_rcp_f32 v128, v128
    v_rcp_f32 v129, v129
    v_rcp_f32 v130, v130
    v_rcp_f32 v131, v131
    v_rcp_f32 v132, v132
    v_rcp_f32 v133, v133
    v_rcp_f32 v134, v134
    v_rcp_f32 v135, v135
    v_pk_mul_f32 v[220:221], v[152:153], v[120:121]
    v_pk_mul_f32 v[222:223], v[160:161], v[128:129]
    v_pk_fma_f32 v[220:221], v[154:155], v[122:123], v[220:221]
    v_pk_fma_f32 v[222:223], v[162:163], v[130:131], v[222:223]
    v_pk_fma_f32 v[220:221], v[156:157], v[124:125], v[220:221]
    v_pk_fma_f32 v[222:223], v[164:165], v[132:133], v[222:223]
    v_pk_fma_f32 v[220:221], v[158:159], v[126:127], v[220:221]
    v_pk_fma_f32 v[222:223], v[166:167], v[134:135], v[222:223]
    s_cbranch_scc1 FINS_0
    s_setprio 1
    v_mfma_f32_16x16x32_bf16 v[120:123], v[200:203], v[98:101], 0
    v_cvt_f64_f32 v[228:229], v244
    v_cvt_f64_f32 v[230:231], v245
    v_mfma_f32_16x16x32_bf16 v[120:123], v[184:187], v[32:35], v[120:123]
    v_cvt_f64_f32 v[232:233], v246
    v_cvt_f64_f32 v[234:235], v247
    v_mfma_f32_16x16x32_bf16 v[120:123], v[188:191], v[36:39], v[120:123]
    v_add_u32 v4, 0x1800, v4
    v_add_u32 v2, 0x1800, v2
    v_add_u32 v3, 0x1800, v3
    v_mfma_f32_16x16x32_bf16 v[124:127], v[204:207], v[96:99], 0
    v_exp_f32 v136, v136
    v_mfma_f32_16x16x32_bf16 v[124:127], v[192:195], v[32:35], v[124:127]
    v_exp_f32 v137, v137
    v_mfma_f32_16x16x32_bf16 v[124:127], v[196:199], v[36:39], v[124:127]
    v_exp_f32 v138, v138
    v_mfma_f32_16x16x32_bf16 v[128:131], v[200:203], v[104:107], 0
    v_exp_f32 v139, v139
    v_mfma_f32_16x16x32_bf16 v[128:131], v[184:187], v[40:43], v[128:131]
    v_exp_f32 v140, v140
    v_mfma_f32_16x16x32_bf16 v[128:131], v[188:191], v[44:47], v[128:131]
    v_exp_f32 v141, v141
    v_mfma_f32_16x16x32_bf16 v[132:135], v[204:207], v[102:105], 0
    v_exp_f32 v142, v142
    v_mfma_f32_16x16x32_bf16 v[132:135], v[192:195], v[40:43], v[132:135]
    v_exp_f32 v143, v143
    v_mfma_f32_16x16x32_bf16 v[132:135], v[196:199], v[44:47], v[132:135]
    v_exp_f32 v144, v144
    v_mfma_f32_16x16x32_bf16 v[152:155], v[184:187], v[64:67], 0
    v_exp_f32 v145, v145
    v_mfma_f32_16x16x32_bf16 v[152:155], v[188:191], v[68:71], v[152:155]
    v_exp_f32 v146, v146
    v_mfma_f32_16x16x32_bf16 v[156:159], v[192:195], v[64:67], 0
    v_exp_f32 v147, v147
    v_mfma_f32_16x16x32_bf16 v[156:159], v[196:199], v[68:71], v[156:159]
    v_exp_f32 v148, v148
    v_mfma_f32_16x16x32_bf16 v[160:163], v[184:187], v[72:75], 0
    v_exp_f32 v149, v149
    v_mfma_f32_16x16x32_bf16 v[160:163], v[188:191], v[76:79], v[160:163]
    v_exp_f32 v150, v150
    v_mfma_f32_16x16x32_bf16 v[164:167], v[192:195], v[72:75], 0
    v_exp_f32 v151, v151
    v_mfma_f32_16x16x32_bf16 v[164:167], v[196:199], v[76:79], v[164:167]
    s_setprio 0
    buffer_load_dwordx4 v[214:217], v[248:249], s[28:31], 0 idxen offen
    ds_read_u16 v16, v4 offset:4230
    ds_read_u16 v17, v4 offset:4262
    ds_read_b128 v[236:239], v2 offset:6272
    ds_read_b128 v[240:243], v2 offset:6288
    ds_add_f64 v24, v[228:229] offset:256
    ds_add_f64 v25, v[230:231] offset:256
    ds_add_f64 v24, v[232:233] offset:384
    ds_add_f64 v25, v[234:235] offset:384
    ds_read_b32 v110, v22 offset:640
    ds_read_b32 v111, v23 offset:640
    ds_read_b32 v116, v22 offset:644
    ds_read_b32 v117, v23 offset:644
    s_waitcnt lgkmcnt(0)
    v_pk_mul_f32 v[244:245], v[220:221], 1.0 op_sel_hi:[1,0]
    v_pk_mul_f32 v[246:247], v[222:223], 1.0 op_sel_hi:[1,0]
    v_pk_add_f32 v[136:137], v[136:137], 1.0 op_sel_hi:[1,0]
    v_pk_add_f32 v[138:139], v[138:139], 1.0 op_sel_hi:[1,0]
    v_pk_add_f32 v[140:141], v[140:141], 1.0 op_sel_hi:[1,0]
    v_pk_add_f32 v[142:143], v[142:143], 1.0 op_sel_hi:[1,0]
    v_pk_add_f32 v[144:145], v[144:145], 1.0 op_sel_hi:[1,0]
    v_pk_add_f32 v[146:147], v[146:147], 1.0 op_sel_hi:[1,0]
    v_pk_add_f32 v[148:149], v[148:149], 1.0 op_sel_hi:[1,0]
    v_pk_add_f32 v[150:151], v[150:151], 1.0 op_sel_hi:[1,0]
    v_rcp_f32 v136, v136
    v_rcp_f32 v137, v137
    v_rcp_f32 v138, v138
    v_rcp_f32 v139, v139
    v_rcp_f32 v140, v140
    v_rcp_f32 v141, v141
    v_rcp_f32 v142, v142
    v_rcp_f32 v143, v143
    v_rcp_f32 v144, v144
    v_rcp_f32 v145, v145
    v_rcp_f32 v146, v146
    v_rcp_f32 v147, v147
    v_rcp_f32 v148, v148
    v_rcp_f32 v149, v149
    v_rcp_f32 v150, v150
    v_rcp_f32 v151, v151
    v_pk_mul_f32 v[220:221], v[168:169], v[136:137]
    v_pk_mul_f32 v[222:223], v[176:177], v[144:145]
    v_pk_fma_f32 v[220:221], v[170:171], v[138:139], v[220:221]
    v_pk_fma_f32 v[222:223], v[178:179], v[146:147], v[222:223]
    v_pk_fma_f32 v[220:221], v[172:173], v[140:141], v[220:221]
    v_pk_fma_f32 v[222:223], v[180:181], v[148:149], v[222:223]
    v_pk_fma_f32 v[220:221], v[174:175], v[142:143], v[220:221]
    v_pk_fma_f32 v[222:223], v[182:183], v[150:151], v[222:223]
    s_setprio 1
    v_mfma_f32_16x16x32_bf16 v[136:139], v[200:203], v[110:113], 0
    v_cvt_f64_f32 v[228:229], v244
    v_cvt_f64_f32 v[230:231], v245
    v_mfma_f32_16x16x32_bf16 v[136:139], v[184:187], v[48:51], v[136:139]
    v_cvt_f64_f32 v[232:233], v246
    v_cvt_f64_f32 v[234:235], v247
    v_mfma_f32_16x16x32_bf16 v[136:139], v[188:191], v[52:55], v[136:139]
    v_mad_u32_u24 v24, v16, s11, v6
    v_mad_u32_u24 v25, v17, s11, v6
    v_mfma_f32_16x16x32_bf16 v[140:143], v[204:207], v[108:111], 0
    v_mad_u32_u16 v236, v237, s55, v250
    v_mad_u32_u16 v238, v239, s55, v251
    v_mfma_f32_16x16x32_bf16 v[140:143], v[192:195], v[48:51], v[140:143]
    v_mad_u32_u16 v240, v241, s55, v252
    v_mad_u32_u16 v242, v243, s55, v253
    v_mfma_f32_16x16x32_bf16 v[140:143], v[196:199], v[52:55], v[140:143]
    v_exp_f32 v120, v120
    v_mfma_f32_16x16x32_bf16 v[144:147], v[200:203], v[116:119], 0
    v_exp_f32 v121, v121
    v_mfma_f32_16x16x32_bf16 v[144:147], v[184:187], v[56:59], v[144:147]
    v_exp_f32 v122, v122
    v_mfma_f32_16x16x32_bf16 v[144:147], v[188:191], v[60:63], v[144:147]
    v_exp_f32 v123, v123
    v_mfma_f32_16x16x32_bf16 v[148:151], v[204:207], v[114:117], 0
    v_exp_f32 v124, v124
    v_mfma_f32_16x16x32_bf16 v[148:151], v[192:195], v[56:59], v[148:151]
    v_exp_f32 v125, v125
    v_mfma_f32_16x16x32_bf16 v[148:151], v[196:199], v[60:63], v[148:151]
    v_exp_f32 v126, v126
    v_mfma_f32_16x16x32_bf16 v[168:171], v[184:187], v[80:83], 0
    v_exp_f32 v127, v127
    v_mfma_f32_16x16x32_bf16 v[168:171], v[188:191], v[84:87], v[168:171]
    v_exp_f32 v128, v128
    v_mfma_f32_16x16x32_bf16 v[172:175], v[192:195], v[80:83], 0
    v_exp_f32 v129, v129
    v_mfma_f32_16x16x32_bf16 v[172:175], v[196:199], v[84:87], v[172:175]
    v_exp_f32 v130, v130
    v_mfma_f32_16x16x32_bf16 v[176:179], v[184:187], v[88:91], 0
    v_exp_f32 v131, v131
    v_mfma_f32_16x16x32_bf16 v[176:179], v[188:191], v[92:95], v[176:179]
    v_exp_f32 v132, v132
    v_mfma_f32_16x16x32_bf16 v[180:183], v[192:195], v[88:91], 0
    v_exp_f32 v133, v133
    v_mfma_f32_16x16x32_bf16 v[180:183], v[196:199], v[92:95], v[180:183]
    v_exp_f32 v134, v134
    v_exp_f32 v135, v135
    s_setprio 0
    s_waitcnt vmcnt(1)
    ds_read_b128 v[184:187], v12 offset:0
    ds_read_b128 v[188:191], v13 offset:0
    ds_read_b128 v[192:195], v12 offset:1024
    ds_read_b128 v[196:199], v13 offset:1024
    ds_read_b32 v248, v3 offset:8320
    ds_add_f64 v26, v[228:229] offset:0
    ds_add_f64 v27, v[230:231] offset:0
    ds_add_f64 v26, v[232:233] offset:128
    ds_add_f64 v27, v[234:235] offset:128
    ds_read_b32 v98, v24 offset:512
    ds_read_b32 v99, v25 offset:512
    ds_read_b32 v104, v24 offset:516
    ds_read_b32 v105, v25 offset:516
    s_waitcnt lgkmcnt(9)
    buffer_load_dwordx4 v236, s[24:27], 0 offen offset:0 lds
    buffer_load_dwordx4 v238, s[24:27], 0 offen offset:1024 lds
    buffer_load_dwordx4 v240, s[24:27], 0 offen offset:2048 lds
    buffer_load_dwordx4 v242, s[24:27], 0 offen offset:3072 lds
    s_sub_u32 s51, s51, 1
    s_cmp_eq_u32 s51, 0
    s_waitcnt lgkmcnt(0)
    v_permlane16_swap_b32 v208, v210
    v_permlane16_swap_b32 v209, v211
    v_pk_mul_f32 v[244:245], v[220:221], 1.0 op_sel_hi:[1,0]
    v_pk_mul_f32 v[246:247], v[222:223], 1.0 op_sel_hi:[1,0]
    v_pk_add_f32 v[120:121], v[120:121], 1.0 op_sel_hi:[1,0]
    v_pk_add_f32 v[122:123], v[122:123], 1.0 op_sel_hi:[1,0]
    v_pk_add_f32 v[124:125], v[124:125], 1.0 op_sel_hi:[1,0]
    v_pk_add_f32 v[126:127], v[126:127], 1.0 op_sel_hi:[1,0]
    v_pk_add_f32 v[128:129], v[128:129], 1.0 op_sel_hi:[1,0]
    v_pk_add_f32 v[130:131], v[130:131], 1.0 op_sel_hi:[1,0]
    v_pk_add_f32 v[132:133], v[132:133], 1.0 op_sel_hi:[1,0]
    v_pk_add_f32 v[134:135], v[134:135], 1.0 op_sel_hi:[1,0]
    v_rcp_f32 v120, v120
    v_rcp_f32 v121, v121
    v_rcp_f32 v122, v122
    v_rcp_f32 v123, v123
    v_rcp_f32 v124, v124
    v_rcp_f32 v125, v125
    v_rcp_f32 v126, v126
    v_rcp_f32 v127, v127
    v_rcp_f32 v128, v128
    v_rcp_f32 v129, v129
    v_rcp_f32 v130, v130
    v_rcp_f32 v131, v131
    v_rcp_f32 v132, v132
    v_rcp_f32 v133, v133
    v_rcp_f32 v134, v134
    v_rcp_f32 v135, v135
    v_pk_mul_f32 v[220:221], v[152:153], v[120:121]
    v_pk_mul_f32 v[222:223], v[160:161], v[128:129]
    v_pk_fma_f32 v[220:221], v[154:155], v[122:123], v[220:221]
    v_pk_fma_f32 v[222:223], v[162:163], v[130:131], v[222:223]
    v_pk_fma_f32 v[220:221], v[156:157], v[124:125], v[220:221]
    v_pk_fma_f32 v[222:223], v[164:165], v[132:133], v[222:223]
    v_pk_fma_f32 v[220:221], v[158:159], v[126:127], v[220:221]
    v_pk_fma_f32 v[222:223], v[166:167], v[134:135], v[222:223]
    s_cbranch_scc0 LOOPS
FINS_1:
    v_cvt_f64_f32 v[228:229], v244
    v_cvt_f64_f32 v[230:231], v245
    v_cvt_f64_f32 v[232:233], v246
    v_cvt_f64_f32 v[234:235], v247
    v_exp_f32 v136, v136
    v_exp_f32 v137, v137
    v_exp_f32 v138, v138
    v_exp_f32 v139, v139
    v_exp_f32 v140, v140
    v_exp_f32 v141, v141
    v_exp_f32 v142, v142
    v_exp_f32 v143, v143
    v_exp_f32 v144, v144
    v_exp_f32 v145, v145
    v_exp_f32 v146, v146
    v_exp_f32 v147, v147
    v_exp_f32 v148, v148
    v_exp_f32 v149, v149
    v_exp_f32 v150, v150
    v_exp_f32 v151, v151
    ds_add_f64 v26, v[228:229] offset:256
    ds_add_f64 v27, v[230:231] offset:256
    ds_add_f64 v26, v[232:233] offset:384
    ds_add_f64 v27, v[234:235] offset:384
    s_nop 0
    v_pk_mul_f32 v[244:245], v[220:221], 1.0 op_sel_hi:[1,0]
    v_pk_mul_f32 v[246:247], v[222:223], 1.0 op_sel_hi:[1,0]
    v_pk_add_f32 v[136:137], v[136:137], 1.0 op_sel_hi:[1,0]
    v_pk_add_f32 v[138:139], v[138:139], 1.0 op_sel_hi:[1,0]
    v_pk_add_f32 v[140:141], v[140:141], 1.0 op_sel_hi:[1,0]
    v_pk_add_f32 v[142:143], v[142:143], 1.0 op_sel_hi:[1,0]
    v_pk_add_f32 v[144:145], v[144:145], 1.0 op_sel_hi:[1,0]
    v_pk_add_f32 v[146:147], v[146:147], 1.0 op_sel_hi:[1,0]
    v_pk_add_f32 v[148:149], v[148:149], 1.0 op_sel_hi:[1,0]
    v_pk_add_f32 v[150:151], v[150:151], 1.0 op_sel_hi:[1,0]
    v_rcp_f32 v136, v136
    v_rcp_f32 v137, v137
    v_rcp_f32 v138, v138
    v_rcp_f32 v139, v139
    v_rcp_f32 v140, v140
    v_rcp_f32 v141, v141
    v_rcp_f32 v142, v142
    v_rcp_f32 v143, v143
    v_rcp_f32 v144, v144
    v_rcp_f32 v145, v145
    v_rcp_f32 v146, v146
    v_rcp_f32 v147, v147
    v_rcp_f32 v148, v148
    v_rcp_f32 v149, v149
    v_rcp_f32 v150, v150
    v_rcp_f32 v151, v151
    v_pk_mul_f32 v[220:221], v[168:169], v[136:137]
    v_pk_mul_f32 v[222:223], v[176:177], v[144:145]
    v_pk_fma_f32 v[220:221], v[170:171], v[138:139], v[220:221]
    v_pk_fma_f32 v[222:223], v[178:179], v[146:147], v[222:223]
    v_pk_fma_f32 v[220:221], v[172:173], v[140:141], v[220:221]
    v_pk_fma_f32 v[222:223], v[180:181], v[148:149], v[222:223]
    v_pk_fma_f32 v[220:221], v[174:175], v[142:143], v[220:221]
    v_pk_fma_f32 v[222:223], v[182:183], v[150:151], v[222:223]
    v_cvt_f64_f32 v[228:229], v244
    v_cvt_f64_f32 v[230:231], v245
    v_cvt_f64_f32 v[232:233], v246
    v_cvt_f64_f32 v[234:235], v247
    ds_add_f64 v22, v[228:229] offset:0
    ds_add_f64 v23, v[230:231] offset:0
    ds_add_f64 v22, v[232:233] offset:128
    ds_add_f64 v23, v[234:235] offset:128
    s_nop 0
    v_pk_mul_f32 v[244:245], v[220:221], 1.0 op_sel_hi:[1,0]
    v_pk_mul_f32 v[246:247], v[222:223], 1.0 op_sel_hi:[1,0]
    v_cvt_f64_f32 v[228:229], v244
    v_cvt_f64_f32 v[230:231], v245
    v_cvt_f64_f32 v[232:233], v246
    v_cvt_f64_f32 v[234:235], v247
    ds_add_f64 v22, v[228:229] offset:256
    ds_add_f64 v23, v[230:231] offset:256
    ds_add_f64 v22, v[232:233] offset:384
    ds_add_f64 v23, v[234:235] offset:384
    s_nop 0
    s_branch MAIN_DONE
FINS_2:
    v_cvt_f64_f32 v[228:229], v244
    v_cvt_f64_f32 v[230:231], v245
    v_cvt_f64_f32 v[232:233], v246
    v_cvt_f64_f32 v[234:235], v247
    v_exp_f32 v136, v136
    v_exp_f32 v137, v137
    v_exp_f32 v138, v138
    v_exp_f32 v139, v139
    v_exp_f32 v140, v140
    v_exp_f32 v141, v141
    v_exp_f32 v142, v142
    v_exp_f32 v143, v143
    v_exp_f32 v144, v144
    v_exp_f32 v145, v145
    v_exp_f32 v146, v146
    v_exp_f32 v147, v147
    v_exp_f32 v148, v148
    v_exp_f32 v149, v149
    v_exp_f32 v150, v150
    v_exp_f32 v151, v151
    ds_add_f64 v22, v[228:229] offset:256
    ds_add_f64 v23, v[230:231] offset:256
    ds_add_f64 v22, v[232:233] offset:384
    ds_add_f64 v23, v[234:235] offset:384
    s_nop 0
    v_pk_mul_f32 v[244:245], v[220:221], 1.0 op_sel_hi:[1,0]
    v_pk_mul_f32 v[246:247], v[222:223], 1.0 op_sel_hi:[1,0]
    v_pk_add_f32 v[136:137], v[136:137], 1.0 op_sel_hi:[1,0]
    v_pk_add_f32 v[138:139], v[138:139], 1.0 op_sel_hi:[1,0]
    v_pk_add_f32 v[140:141], v[140:141], 1.0 op_sel_hi:[1,0]
    v_pk_add_f32 v[142:143], v[142:143], 1.0 op_sel_hi:[1,0]
    v_pk_add_f32 v[144:145], v[144:145], 1.0 op_sel_hi:[1,0]
    v_pk_add_f32 v[146:147], v[146:147], 1.0 op_sel_hi:[1,0]
    v_pk_add_f32 v[148:149], v[148:149], 1.0 op_sel_hi:[1,0]
    v_pk_add_f32 v[150:151], v[150:151], 1.0 op_sel_hi:[1,0]
    v_rcp_f32 v136, v136
    v_rcp_f32 v137, v137
    v_rcp_f32 v138, v138
    v_rcp_f32 v139, v139
    v_rcp_f32 v140, v140
    v_rcp_f32 v141, v141
    v_rcp_f32 v142, v142
    v_rcp_f32 v143, v143
    v_rcp_f32 v144, v144
    v_rcp_f32 v145, v145
    v_rcp_f32 v146, v146
    v_rcp_f32 v147, v147
    v_rcp_f32 v148, v148
    v_rcp_f32 v149, v149
    v_rcp_f32 v150, v150
    v_rcp_f32 v151, v151
    v_pk_mul_f32 v[220:221], v[168:169], v[136:137]
    v_pk_mul_f32 v[222:223], v[176:177], v[144:145]
    v_pk_fma_f32 v[220:221], v[170:171], v[138:139], v[220:221]
    v_pk_fma_f32 v[222:223], v[178:179], v[146:147], v[222:223]
    v_pk_fma_f32 v[220:221], v[172:173], v[140:141], v[220:221]
    v_pk_fma_f32 v[222:223], v[180:181], v[148:149], v[222:223]
    v_pk_fma_f32 v[220:221], v[174:175], v[142:143], v[220:221]
    v_pk_fma_f32 v[222:223], v[182:183], v[150:151], v[222:223]
    v_cvt_f64_f32 v[228:229], v244
    v_cvt_f64_f32 v[230:231], v245
    v_cvt_f64_f32 v[232:233], v246
    v_cvt_f64_f32 v[234:235], v247
    ds_add_f64 v24, v[228:229] offset:0
    ds_add_f64 v25, v[230:231] offset:0
    ds_add_f64 v24, v[232:233] offset:128
    ds_add_f64 v25, v[234:235] offset:128
    s_nop 0
    v_pk_mul_f32 v[244:245], v[220:221], 1.0 op_sel_hi:[1,0]
    v_pk_mul_f32 v[246:247], v[222:223], 1.0 op_sel_hi:[1,0]
    v_cvt_f64_f32 v[228:229], v244
    v_cvt_f64_f32 v[230:231], v245
    v_cvt_f64_f32 v[232:233], v246
    v_cvt_f64_f32 v[234:235], v247
    ds_add_f64 v24, v[228:229] offset:256
    ds_add_f64 v25, v[230:231] offset:256
    ds_add_f64 v24, v[232:233] offset:384
    ds_add_f64 v25, v[234:235] offset:384
    s_nop 0
    s_branch MAIN_DONE
FINS_0:
    v_cvt_f64_f32 v[228:229], v244
    v_cvt_f64_f32 v[230:231], v245
    v_cvt_f64_f32 v[232:233], v246
    v_cvt_f64_f32 v[234:235], v247
    v_exp_f32 v136, v136
    v_exp_f32 v137, v137
    v_exp_f32 v138, v138
    v_exp_f32 v139, v139
    v_exp_f32 v140, v140
    v_exp_f32 v141, v141
    v_exp_f32 v142, v142
    v_exp_f32 v143, v143
    v_exp_f32 v144, v144
    v_exp_f32 v145, v145
    v_exp_f32 v146, v146
    v_exp_f32 v147, v147
    v_exp_f32 v148, v148
    v_exp_f32 v149, v149
    v_exp_f32 v150, v150
    v_exp_f32 v151, v151
    ds_add_f64 v24, v[228:229] offset:256
    ds_add_f64 v25, v[230:231] offset:256
    ds_add_f64 v24, v[232:233] offset:384
    ds_add_f64 v25, v[234:235] offset:384
    s_nop 0
    v_pk_mul_f32 v[244:245], v[220:221], 1.0 op_sel_hi:[1,0]
    v_pk_mul_f32 v[246:247], v[222:223], 1.0 op_sel_hi:[1,0]
    v_pk_add_f32 v[136:137], v[136:137], 1.0 op_sel_hi:[1,0]
    v_pk_add_f32 v[138:139], v[138:139], 1.0 op_sel_hi:[1,0]
    v_pk_add_f32 v[140:141], v[140:141], 1.0 op_sel_hi:[1,0]
    v_pk_add_f32 v[142:143], v[142:143], 1.0 op_sel_hi:[1,0]
    v_pk_add_f32 v[144:145], v[144:145], 1.0 op_sel_hi:[1,0]
    v_pk_add_f32 v[146:147], v[146:147], 1.0 op_sel_hi:[1,0]
    v_pk_add_f32 v[148:149], v[148:149], 1.0 op_sel_hi:[1,0]
    v_pk_add_f32 v[150:151], v[150:151], 1.0 op_sel_hi:[1,0]
    v_rcp_f32 v136, v136
    v_rcp_f32 v137, v137
    v_rcp_f32 v138, v138
    v_rcp_f32 v139, v139
    v_rcp_f32 v140, v140
    v_rcp_f32 v141, v141
    v_rcp_f32 v142, v142
    v_rcp_f32 v143, v143
    v_rcp_f32 v144, v144
    v_rcp_f32 v145, v145
    v_rcp_f32 v146, v146
    v_rcp_f32 v147, v147
    v_rcp_f32 v148, v148
    v_rcp_f32 v149, v149
    v_rcp_f32 v150, v150
    v_rcp_f32 v151, v151
    v_pk_mul_f32 v[220:221], v[168:169], v[136:137]
    v_pk_mul_f32 v[222:223], v[176:177], v[144:145]
    v_pk_fma_f32 v[220:221], v[170:171], v[138:139], v[220:221]
    v_pk_fma_f32 v[222:223], v[178:179], v[146:147], v[222:223]
    v_pk_fma_f32 v[220:221], v[172:173], v[140:141], v[220:221]
    v_pk_fma_f32 v[222:223], v[180:181], v[148:149], v[222:223]
    v_pk_fma_f32 v[220:221], v[174:175], v[142:143], v[220:221]
    v_pk_fma_f32 v[222:223], v[182:183], v[150:151], v[222:223]
    v_cvt_f64_f32 v[228:229], v244
    v_cvt_f64_f32 v[230:231], v245
    v_cvt_f64_f32 v[232:233], v246
    v_cvt_f64_f32 v[234:235], v247
    ds_add_f64 v26, v[228:229] offset:0
    ds_add_f64 v27, v[230:231] offset:0
    ds_add_f64 v26, v[232:233] offset:128
    ds_add_f64 v27, v[234:235] offset:128
    s_nop 0
    v_pk_mul_f32 v[244:245], v[220:221], 1.0 op_sel_hi:[1,0]
    v_pk_mul_f32 v[246:247], v[222:223], 1.0 op_sel_hi:[1,0]
    v_cvt_f64_f32 v[228:229], v244
    v_cvt_f64_f32 v[230:231], v245
    v_cvt_f64_f32 v[232:233], v246
    v_cvt_f64_f32 v[234:235], v247
    ds_add_f64 v26, v[228:229] offset:256
    ds_add_f64 v27, v[230:231] offset:256
    ds_add_f64 v26, v[232:233] offset:384
    ds_add_f64 v27, v[234:235] offset:384
    s_nop 0
    s_branch MAIN_DONE

.section .rodata,"a"
.p2align 6
.amdhsa_kernel gather_scatter__edge_featured_mpnn_egc__graph_kernel
  .amdhsa_next_free_vgpr 254
  .amdhsa_next_free_sgpr 102
  .amdhsa_accum_offset 256
  .amdhsa_group_segment_fixed_size 0
  .amdhsa_kernarg_size 80
  .amdhsa_user_sgpr_count 2
  .amdhsa_user_sgpr_kernarg_segment_ptr 1
  .amdhsa_system_sgpr_workgroup_id_x 1
  .amdhsa_float_denorm_mode_32 3
.end_amdhsa_kernel
```
